```python
import torch

def _softmax(x, axis=-1):
    return torch.softmax(x, dim=axis)
def _gelu(x):
    return torch.nn.functional.gelu(x, approximate="tanh")
def _silu(x):
    return torch.nn.functional.silu(x)
def _sigmoid(x):
    return torch.sigmoid(x)
def _layernorm(x, axis=-1, eps=1e-5):
    m = x.mean(dim=axis, keepdim=True)
    v = x.var(dim=axis, keepdim=True, unbiased=False)
    return (x - m) / torch.sqrt(v + eps)
def _scatter_add(tgt, idx, src, axis=0):
    return tgt.clone().index_add_(axis, idx, src)
def _segment_sum(src, seg, n):
    out = torch.zeros((n,) + src.shape[1:], dtype=src.dtype)
    return out.index_add_(0, seg, src)
def _pad(x, pw):
    flat = tuple(v for pair in reversed(pw) for v in pair)
    return torch.nn.functional.pad(x, flat)

kernel_name = 'recurrent_scan__spectral_gfnet__mixer_channel_mlp__prompt'

def setup_inputs():

    _w = (lambda a: (lambda t: t.to(torch.bfloat16) if t.is_floating_point() else t)(torch.as_tensor(a)))
    def _A_setup():
        B, S, D = 1, 2048, 512
        Df = D // 2 + 1
        return {
            "x": _w((lambda *s: torch.randn(*s, dtype=torch.bfloat16) * 0.05)(B, S, D)),
            "w_r": _w((lambda *s: torch.randn(*s, dtype=torch.bfloat16) * 0.8)(S, Df) * 0.02),
            "w_i": _w((lambda *s: torch.randn(*s, dtype=torch.bfloat16) * 0.8)(S, Df) * 0.02),
        }
    _A_in = _A_setup()

    def _B_setup():
        B, S, D, F = 1, 2048, 512, 1792
        return {
            "x": _w((lambda *s: torch.randn(*s, dtype=torch.bfloat16) * 0.05)(B, S, D)),
            "w1": _w((lambda *s: torch.randn(*s, dtype=torch.bfloat16) * 0.8)(D, F) * (D ** -0.5)),
            "b1": _w((lambda *s: torch.randn(*s, dtype=torch.bfloat16) * 0.8)(F)),
            "w2": _w((lambda *s: torch.randn(*s, dtype=torch.bfloat16) * 0.8)(F, D) * (F ** -0.5)),
            "b2": _w((lambda *s: torch.randn(*s, dtype=torch.bfloat16) * 0.2)(D)),
        }
    _B_in = _B_setup()

    return {
        "A_x": _A_in["x"],
        "A_w_r": _A_in["w_r"],
        "A_w_i": _A_in["w_i"],
        "B_x": _B_in["x"],
        "B_w1": _B_in["w1"],
        "B_b1": _B_in["b1"],
        "B_w2": _B_in["w2"],
        "B_b2": _B_in["b2"],
    }

def reference(A_x, A_w_r, A_w_i, B_x, B_w1, B_b1, B_w2, B_b2):
    def _A_ref(x, w_r, w_i):
        B, S, D = x.shape
        X = (lambda x, axes=(-2,-1): torch.fft.rfft2(x.float(), dim=axes))(x, axes=(-2, -1))
        W = w_r + 1j * w_i
        X = X * W
        y = (lambda x, s, axes=(-2,-1): torch.fft.irfft2(x, s=s, dim=axes).to(torch.bfloat16))(X, (S, D), axes=(-2, -1))
        return y

    def _B_ref(x, w1, b1, w2, b2):
        y = _layernorm(x, axis=-1)
        h = _gelu(torch.einsum("bsd,df->bsf", y, w1) + b1)
        return torch.einsum("bsf,fd->bsd", h, w2) + b2

    x = A_x
    xn = _layernorm(x, axis=-1)
    s = _A_ref(xn, A_w_r, A_w_i)
    g = _silu(_B_ref(xn, B_w1, B_b1, B_w2, B_b2))
    return x + s * g
```

```asm
; @launch grid=(256,1,1) block=(256,1,1) lds=163840
.amdgcn_target "amdgcn-amd-amdhsa--gfx950"
.text
.globl recurrent_scan__spectral_gfnet__mixer_channel_mlp__prompt_kernel
.p2align 8
.type recurrent_scan__spectral_gfnet__mixer_channel_mlp__prompt_kernel,@function
recurrent_scan__spectral_gfnet__mixer_channel_mlp__prompt_kernel:
    s_cmp_ge_u32 s2, 256
    s_cbranch_scc1 EXIT
    s_load_dwordx2 s[4:5], s[0:1], 0
    s_load_dwordx2 s[16:17], s[0:1], 32
    s_load_dwordx2 s[40:41], s[0:1], 80
    s_getpc_b64 s[52:53]
PCREF:
    v_lshlrev_b32 v230, 7, v0
    v_min_u32 v230, CODE_END-PCREF, v230
    v_mov_b32 v231, s53
    v_add_co_u32 v230, vcc, s52, v230
    s_nop 1
    v_addc_co_u32 v231, vcc, 0, v231, vcc
    global_load_dword v223, v[230:231], off
    v_lshrrev_b32 v1, 6, v0
    v_and_b32 v0, 63, v0
    s_and_b32 s52, s2, 7
    v_readfirstlane_b32 s44, v1
    s_lshr_b32 s53, s2, 3
    v_and_b32 v1, 15, v0
    v_lshrrev_b32 v2, 4, v0
    s_lshr_b32 s54, s52, 1
    s_and_b32 s55, s53, 3
    s_lshl2_add_u32 s45, s54, s55
    s_and_b32 s54, s52, 1
    s_lshr_b32 s50, s53, 2
    s_lshl3_add_u32 s46, s54, s50
    s_lshl2_add_u32 s49, s52, s55
    s_and_b32 s54, s53, 1
    s_lshl1_add_u32 s47, s52, s54
    s_lshr_b32 s48, s53, 1
    s_mul_i32 s66, s44, 33792
    s_mov_b32 s6, 2097152
    s_mov_b32 s7, 0x20000
    s_mov_b32 s18, 1835008
    s_mov_b32 s19, 0x20000
    s_mov_b32 s42, 268435456
    s_mov_b32 s43, 0x20000
    s_add_u32 s52, s45, s46
    s_and_b32 s52, s52, 3
    s_lshl2_add_u32 s53, s52, s44
    s_lshl_b32 s51, s53, 6
    s_lshl2_add_u32 s54, s45, s44
    s_lshl_b32 s54, s54, 10
    s_and_b32 s55, s44, 1
    s_lshl_b32 s55, s55, 2
    v_and_b32 v192, 7, v0
    v_xor_b32 v192, v192, v2
    v_xor_b32 v192, s55, v192
    v_lshrrev_b32 v40, 3, v0
    v_lshlrev_b32 v40, 16, v40
    v_lshl_add_u32 v40, v192, 4, v40
    v_add_u32 v40, s54, v40
    v_xor_b32 v41, 64, v40
    v_add_u32 v42, 1046528, v40
    v_add_u32 v43, 1569792, v41
    v_add_u32 v41, 523264, v41
    s_and_b32 s59, s51, 0x380
    s_mul_i32 s55, s46, 224
    s_mul_i32 s52, s53, 114688
    s_add_u32 s82, s52, s55
    s_cmp_lg_u32 s2, 0
    s_cbranch_scc1 NOZERO
    v_mov_b32 v224, 0
    v_mov_b32 v225, 0
    v_mov_b32 v226, 0
    v_mov_b32 v227, 0
    s_mul_i32 s52, s44, 3072
    s_add_u32 s52, s52, 12582912
    v_lshlrev_b32 v228, 4, v0
    s_waitcnt lgkmcnt(0)
    buffer_store_dwordx4 v[224:227], v228, s[40:43], s52 offen offset:0 sc1
    buffer_store_dwordx4 v[224:227], v228, s[40:43], s52 offen offset:1024 sc1
    buffer_store_dwordx4 v[224:227], v228, s[40:43], s52 offen offset:2048 sc1
NOZERO:
    s_waitcnt lgkmcnt(0)
    s_add_u32 m0, s66, 18432
    s_xor_b32 s57, s59, 0
    buffer_load_dwordx4 v40, s[4:7], s57 offen offset:0 lds
    buffer_load_dwordx4 v41, s[4:7], s57 offen offset:1024 lds
    buffer_load_dwordx4 v42, s[4:7], s57 offen offset:2048 lds
    buffer_load_dwordx4 v43, s[4:7], s57 offen offset:3072 lds
    s_movk_i32 s76, 3360
    s_movk_i32 s77, 3584
    s_movk_i32 s78, -1792
    v_lshlrev_b32 v195, 8, v0
    v_lshlrev_b32 v196, 4, v0
    v_mul_hi_u32_u24 v192, 1198592, v195
    v_and_b32 v193, 4, v192
    v_mad_u32_u24 v5, v192, s76, v196
    v_mad_u32_u24 v5, v193, s77, v5
    s_add_u32 m0, s66, 26624
    s_nop 0
    buffer_load_dwordx4 v5, s[16:19], s82 offen offset:0 lds
    v_add_u32 v195, 16384, v195
    v_mul_hi_u32_u24 v192, 1198592, v195
    v_and_b32 v193, 4, v192
    v_mad_u32_u24 v6, v192, s76, v196
    v_mad_u32_u24 v6, v193, s77, v6
    v_and_b32 v194, 8, v192
    v_mad_i32_i24 v6, v194, s78, v6
    buffer_load_dwordx4 v6, s[16:19], s82 offen offset:1024 lds
    v_add_u32 v195, 16384, v195
    v_mul_hi_u32_u24 v192, 1198592, v195
    v_and_b32 v193, 4, v192
    v_mad_u32_u24 v7, v192, s76, v196
    v_mad_u32_u24 v7, v193, s77, v7
    v_and_b32 v194, 8, v192
    v_mad_i32_i24 v7, v194, s78, v7
    buffer_load_dwordx4 v7, s[16:19], s82 offen offset:2048 lds
    v_add_u32 v195, 16384, v195
    v_mul_hi_u32_u24 v192, 1198592, v195
    v_and_b32 v193, 4, v192
    v_mad_u32_u24 v8, v192, s76, v196
    v_mad_u32_u24 v8, v193, s77, v8
    v_and_b32 v194, 8, v192
    v_mad_i32_i24 v8, v194, s78, v8
    buffer_load_dwordx4 v8, s[16:19], s82 offen offset:3072 lds
    v_add_u32 v195, 16384, v195
    v_add_u32 v196, 4096, v196
    v_mul_hi_u32_u24 v192, 1198592, v195
    v_and_b32 v193, 4, v192
    v_mad_u32_u24 v9, v192, s76, v196
    v_mad_u32_u24 v9, v193, s77, v9
    s_add_u32 m0, s66, 30720
    s_nop 0
    buffer_load_dwordx4 v9, s[16:19], s82 offen offset:0 lds
    v_add_u32 v195, 16384, v195
    v_mul_hi_u32_u24 v192, 1198592, v195
    v_and_b32 v193, 4, v192
    v_mad_u32_u24 v10, v192, s76, v196
    v_mad_u32_u24 v10, v193, s77, v10
    v_and_b32 v194, 8, v192
    v_mad_i32_i24 v10, v194, s78, v10
    buffer_load_dwordx4 v10, s[16:19], s82 offen offset:1024 lds
    v_add_u32 v195, 16384, v195
    v_mul_hi_u32_u24 v192, 1198592, v195
    v_and_b32 v193, 4, v192
    v_mad_u32_u24 v11, v192, s76, v196
    v_mad_u32_u24 v11, v193, s77, v11
    v_and_b32 v194, 8, v192
    v_mad_i32_i24 v11, v194, s78, v11
    buffer_load_dwordx4 v11, s[16:19], s82 offen offset:2048 lds
    s_xor_b32 s52, s53, 4
    s_mul_i32 s52, s52, 114688
    s_add_u32 s83, s52, s55
    s_xor_b32 s52, s53, 8
    s_mul_i32 s52, s52, 114688
    s_add_u32 s84, s52, s55
    s_xor_b32 s52, s53, 12
    s_mul_i32 s52, s52, 114688
    s_add_u32 s85, s52, s55
    s_load_dwordx2 s[20:21], s[0:1], 40
    s_load_dwordx2 s[24:25], s[0:1], 48
    s_load_dwordx2 s[8:9], s[0:1], 8
    s_load_dwordx2 s[12:13], s[0:1], 16
    s_load_dwordx2 s[28:29], s[0:1], 56
    s_load_dwordx2 s[32:33], s[0:1], 64
    s_load_dwordx2 s[36:37], s[0:1], 72
    s_mov_b32 s22, 3584
    s_mov_b32 s23, 0x20000
    s_mov_b32 s26, 1835008
    s_mov_b32 s27, 0x20000
    s_mov_b32 s10, 1052672
    s_mov_b32 s11, 0x20000
    s_mov_b32 s14, 1052672
    s_mov_b32 s15, 0x20000
    s_mov_b32 s30, 1024
    s_mov_b32 s31, 0x20000
    s_mov_b32 s34, 2097152
    s_mov_b32 s35, 0x20000
    s_mov_b32 s38, 256
    s_mov_b32 s39, 0x20000
    s_sub_u32 s61, 32, s47
    s_cmp_eq_u32 s47, 0
    s_cselect_b32 s61, 16, s61
    s_cmp_lt_u32 s44, 2
    s_cselect_b32 s62, s47, s61
    v_lshrrev_b32 v192, 1, v2
    v_and_b32 v193, 1, v2
    v_lshlrev_b32 v192, 4, v192
    v_lshl_add_u32 v192, v193, 2, v192
    v_lshrrev_b32 v193, 2, v1
    v_add_u32 v192, v192, v193
    v_mul_u32_u24 v192, 224, v192
    v_and_b32 v193, 3, v1
    v_lshl_add_u32 v192, v193, 3, v192
    v_lshlrev_b32 v194, 4, v0
    v_cmp_eq_u32 s[76:77], 1, v193
    v_cmp_eq_u32 s[78:79], 2, v193
    v_cmp_eq_u32 s[80:81], 3, v193
    s_xor_b32 s52, s44, 0
    s_mul_i32 s53, s52, 33792
    s_lshl_b32 s52, s52, 11
    s_add_u32 s52, s52, 135168
    v_add_u32 v12, s53, v192
    v_add_u32 v16, s52, v194
    v_mov_b32 v20, 0x3f803f80
    s_xor_b32 s52, s44, 1
    s_mul_i32 s53, s52, 33792
    s_lshl_b32 s52, s52, 11
    s_add_u32 s52, s52, 135168
    v_add_u32 v13, s53, v192
    v_add_u32 v17, s52, v194
    v_mov_b32 v21, 0x3f803f80
    s_xor_b32 s52, s44, 2
    s_mul_i32 s53, s52, 33792
    s_lshl_b32 s52, s52, 11
    s_add_u32 s52, s52, 135168
    v_add_u32 v14, s53, v192
    v_add_u32 v18, s52, v194
    v_mov_b32 v22, 0x3f803f80
    s_xor_b32 s52, s44, 3
    s_mul_i32 s53, s52, 33792
    s_lshl_b32 s52, s52, 11
    s_add_u32 s52, s52, 135168
    v_add_u32 v15, s53, v192
    v_add_u32 v19, s52, v194
    v_mov_b32 v23, 0x3f803f80
    v_lshrrev_b32 v195, 1, v1
    v_xor_b32 v195, v195, v2
    v_lshlrev_b32 v195, 4, v195
    v_lshl_add_u32 v195, v1, 7, v195
    v_add_u32 v44, s66, v195
    v_xor_b32 v45, 64, v44
    v_and_b32 v48, 1, v1
    v_lshlrev_b32 v48, 31, v48
    v_xor_b32 v48, -1.0, v48
    s_lshl_b32 s52, s46, 4
    s_add_u32 s52, s52, 1
    v_add_u32 v192, s52, v1
    v_cvt_f32_u32 v192, v192
    v_mul_f32 v192, 0x3b000000, v192
    v_lshlrev_b32 v193, 3, v2
    s_xor_b32 s52, s51, 0
    s_lshr_b32 s52, s52, 1
    v_add_u32 v194, s52, v193
    v_cvt_f32_u32 v194, v194
    v_mul_f32 v194, v194, v192
    v_cos_f32 v196, v194
    v_sin_f32 v204, v194
    v_add_f32 v194, v194, v192
    v_cos_f32 v197, v194
    v_sin_f32 v205, v194
    v_add_f32 v194, v194, v192
    v_cos_f32 v198, v194
    v_sin_f32 v206, v194
    v_add_f32 v194, v194, v192
    v_cos_f32 v199, v194
    v_sin_f32 v207, v194
    v_add_f32 v194, v194, v192
    v_cos_f32 v200, v194
    v_sin_f32 v208, v194
    v_add_f32 v194, v194, v192
    v_cos_f32 v201, v194
    v_sin_f32 v209, v194
    v_add_f32 v194, v194, v192
    v_cos_f32 v202, v194
    v_sin_f32 v210, v194
    v_add_f32 v194, v194, v192
    v_cos_f32 v203, v194
    v_sin_f32 v211, v194
    v_cvt_pk_bf16_f32 v212, v196, v197
    v_cvt_pk_bf16_f32 v216, -v204, -v205
    v_cvt_pk_bf16_f32 v213, v198, v199
    v_cvt_pk_bf16_f32 v217, -v206, -v207
    v_cvt_pk_bf16_f32 v214, v200, v201
    v_cvt_pk_bf16_f32 v218, -v208, -v209
    v_cvt_pk_bf16_f32 v215, v202, v203
    v_cvt_pk_bf16_f32 v219, -v210, -v211
    ds_write_b128 v16, v[212:215] offset:0
    ds_write_b128 v16, v[216:219] offset:1024
    s_xor_b32 s52, s51, 256
    s_lshr_b32 s52, s52, 1
    v_add_u32 v194, s52, v193
    v_cvt_f32_u32 v194, v194
    v_mul_f32 v194, v194, v192
    v_cos_f32 v196, v194
    v_sin_f32 v204, v194
    v_add_f32 v194, v194, v192
    v_cos_f32 v197, v194
    v_sin_f32 v205, v194
    v_add_f32 v194, v194, v192
    v_cos_f32 v198, v194
    v_sin_f32 v206, v194
    v_add_f32 v194, v194, v192
    v_cos_f32 v199, v194
    v_sin_f32 v207, v194
    v_add_f32 v194, v194, v192
    v_cos_f32 v200, v194
    v_sin_f32 v208, v194
    v_add_f32 v194, v194, v192
    v_cos_f32 v201, v194
    v_sin_f32 v209, v194
    v_add_f32 v194, v194, v192
    v_cos_f32 v202, v194
    v_sin_f32 v210, v194
    v_add_f32 v194, v194, v192
    v_cos_f32 v203, v194
    v_sin_f32 v211, v194
    v_cvt_pk_bf16_f32 v212, v196, v197
    v_cvt_pk_bf16_f32 v216, -v204, -v205
    v_cvt_pk_bf16_f32 v213, v198, v199
    v_cvt_pk_bf16_f32 v217, -v206, -v207
    v_cvt_pk_bf16_f32 v214, v200, v201
    v_cvt_pk_bf16_f32 v218, -v208, -v209
    v_cvt_pk_bf16_f32 v215, v202, v203
    v_cvt_pk_bf16_f32 v219, -v210, -v211
    ds_write_b128 v16, v[212:215] offset:8192
    ds_write_b128 v16, v[216:219] offset:9216
    v_cvt_f32_u32 v192, v1
    v_cvt_f32_u32 v193, v2
    v_mul_f32 v192, 0x3d000000, v192
    v_mul_f32 v193, 4.0, v193
    v_mul_f32 v193, v193, v192
    v_cos_f32 v196, v193
    v_sin_f32 v204, v193
    v_add_f32 v193, v193, v192
    v_cos_f32 v197, v193
    v_sin_f32 v205, v193
    v_add_f32 v193, v193, v192
    v_cos_f32 v198, v193
    v_sin_f32 v206, v193
    v_add_f32 v193, v193, v192
    v_cos_f32 v199, v193
    v_sin_f32 v207, v193
    v_fmamk_f32 v193, v192, 0x41500000, v193
    v_cos_f32 v200, v193
    v_sin_f32 v208, v193
    v_add_f32 v193, v193, v192
    v_cos_f32 v201, v193
    v_sin_f32 v209, v193
    v_add_f32 v193, v193, v192
    v_cos_f32 v202, v193
    v_sin_f32 v210, v193
    v_add_f32 v193, v193, v192
    v_cos_f32 v203, v193
    v_sin_f32 v211, v193
    v_cvt_pk_bf16_f32 v24, v196, v197
    v_cvt_pk_bf16_f32 v28, v204, v205
    v_cvt_pk_bf16_f32 v32, v196, -v197
    v_cvt_pk_bf16_f32 v36, v204, -v205
    v_cvt_pk_bf16_f32 v25, v198, v199
    v_cvt_pk_bf16_f32 v29, v206, v207
    v_cvt_pk_bf16_f32 v33, v198, -v199
    v_cvt_pk_bf16_f32 v37, v206, -v207
    v_cvt_pk_bf16_f32 v26, v200, v201
    v_cvt_pk_bf16_f32 v30, v208, v209
    v_cvt_pk_bf16_f32 v34, v200, -v201
    v_cvt_pk_bf16_f32 v38, v208, -v209
    v_cvt_pk_bf16_f32 v27, v202, v203
    v_cvt_pk_bf16_f32 v31, v210, v211
    v_cvt_pk_bf16_f32 v35, v202, -v203
    v_cvt_pk_bf16_f32 v39, v210, -v211
    s_and_b32 s52, s49, 3
    s_lshl1_add_u32 s52, s52, s50
    s_cmp_ge_u32 s52, 7
    s_cselect_b32 s53, 7, 0
    s_sub_u32 s52, s52, s53
    s_lshl_b32 s65, s52, 12
    s_mul_i32 s52, s44, 458752
    s_lshl_b32 s53, s50, 7
    s_add_u32 s52, s52, s53
    v_lshrrev_b32 v212, 3, v0
    v_and_b32 v213, 7, v0
    v_and_b32 v214, 1, v2
    v_lshlrev_b32 v214, 2, v214
    v_xor_b32 v213, v213, v214
    v_lshlrev_b32 v212, 10, v212
    v_lshl_add_u32 v212, v213, 4, v212
    v_add_u32 v49, s52, v212
    v_add_u32 v50, 7168, v49
    v_add_u32 v51, 14336, v49
    v_add_u32 v52, 21504, v49
    v_lshrrev_b32 v212, 2, v1
    v_lshrrev_b32 v213, 1, v2
    v_lshl_add_u32 v213, v213, 3, v212
    v_lshlrev_b32 v213, 7, v213
    v_lshrrev_b32 v212, 1, v212
    s_and_b32 s52, s44, 1
    v_xor_b32 v212, s52, v212
    v_lshl_add_u32 v213, v212, 6, v213
    v_and_b32 v212, 1, v1
    v_lshl_add_u32 v213, v212, 5, v213
    v_lshl_add_u32 v213, v214, 2, v213
    v_and_b32 v212, 2, v1
    v_lshl_add_u32 v213, v212, 2, v213
    v_add_u32 v3, s66, v213
    v_xor_b32 v4, 64, v3
    s_add_u32 m0, s66, 22528
    s_xor_b32 s57, s59, 128
    buffer_load_dwordx4 v40, s[4:7], s57 offen offset:0 lds
    buffer_load_dwordx4 v41, s[4:7], s57 offen offset:1024 lds
    buffer_load_dwordx4 v42, s[4:7], s57 offen offset:2048 lds
    buffer_load_dwordx4 v43, s[4:7], s57 offen offset:3072 lds
    s_and_b32 s54, s44, 1
    s_lshl_b32 s54, s54, 10
    s_add_u32 s54, s54, s62
    v_lshlrev_b32 v212, 5, v1
    v_add_u32 v212, s54, v212
    v_cvt_f32_u32 v212, v212
    v_cvt_f32_u32 v213, v2
    v_mul_f32 v212, 0x3a000000, v212
    v_mul_f32 v213, 4.0, v213
    v_mul_f32 v213, v213, v212
    v_cos_f32 v214, v213
    v_sin_f32 v215, v213
    v_add_f32 v213, v213, v212
    v_cvt_pk_bf16_f32 v128, v214, v215
    v_cvt_pk_bf16_f32 v144, -v215, v214
    v_cvt_pk_bf16_f32 v160, v214, v215
    v_cvt_pk_bf16_f32 v176, -v215, v214
    v_cos_f32 v214, v213
    v_sin_f32 v215, v213
    v_add_f32 v213, v213, v212
    v_cvt_pk_bf16_f32 v129, v214, v215
    v_cvt_pk_bf16_f32 v145, -v215, v214
    v_cvt_pk_bf16_f32 v161, -v215, v214
    v_cvt_pk_bf16_f32 v177, -v214, -v215
    v_cos_f32 v214, v213
    v_sin_f32 v215, v213
    v_add_f32 v213, v213, v212
    v_cvt_pk_bf16_f32 v130, v214, v215
    v_cvt_pk_bf16_f32 v146, -v215, v214
    v_cvt_pk_bf16_f32 v162, -v214, -v215
    v_cvt_pk_bf16_f32 v178, v215, -v214
    v_cos_f32 v214, v213
    v_sin_f32 v215, v213
    v_fmamk_f32 v213, v212, 0x41500000, v213
    v_cvt_pk_bf16_f32 v131, v214, v215
    v_cvt_pk_bf16_f32 v147, -v215, v214
    v_cvt_pk_bf16_f32 v163, v215, -v214
    v_cvt_pk_bf16_f32 v179, v214, v215
    v_cos_f32 v214, v213
    v_sin_f32 v215, v213
    v_add_f32 v213, v213, v212
    v_cvt_pk_bf16_f32 v132, v214, v215
    v_cvt_pk_bf16_f32 v148, -v215, v214
    v_cvt_pk_bf16_f32 v164, v214, v215
    v_cvt_pk_bf16_f32 v180, -v215, v214
    v_cos_f32 v214, v213
    v_sin_f32 v215, v213
    v_add_f32 v213, v213, v212
    v_cvt_pk_bf16_f32 v133, v214, v215
    v_cvt_pk_bf16_f32 v149, -v215, v214
    v_cvt_pk_bf16_f32 v165, -v215, v214
    v_cvt_pk_bf16_f32 v181, -v214, -v215
    v_cos_f32 v214, v213
    v_sin_f32 v215, v213
    v_add_f32 v213, v213, v212
    v_cvt_pk_bf16_f32 v134, v214, v215
    v_cvt_pk_bf16_f32 v150, -v215, v214
    v_cvt_pk_bf16_f32 v166, -v214, -v215
    v_cvt_pk_bf16_f32 v182, v215, -v214
    v_cos_f32 v214, v213
    v_sin_f32 v215, v213
    v_fmamk_f32 v213, v212, 0x41500000, v213
    v_cvt_pk_bf16_f32 v135, v214, v215
    v_cvt_pk_bf16_f32 v151, -v215, v214
    v_cvt_pk_bf16_f32 v167, v215, -v214
    v_cvt_pk_bf16_f32 v183, v214, v215
    v_cos_f32 v214, v213
    v_sin_f32 v215, v213
    v_add_f32 v213, v213, v212
    v_cvt_pk_bf16_f32 v136, v214, v215
    v_cvt_pk_bf16_f32 v152, -v215, v214
    v_cvt_pk_bf16_f32 v168, v214, v215
    v_cvt_pk_bf16_f32 v184, -v215, v214
    v_cos_f32 v214, v213
    v_sin_f32 v215, v213
    v_add_f32 v213, v213, v212
    v_cvt_pk_bf16_f32 v137, v214, v215
    v_cvt_pk_bf16_f32 v153, -v215, v214
    v_cvt_pk_bf16_f32 v169, -v215, v214
    v_cvt_pk_bf16_f32 v185, -v214, -v215
    v_cos_f32 v214, v213
    v_sin_f32 v215, v213
    v_add_f32 v213, v213, v212
    v_cvt_pk_bf16_f32 v138, v214, v215
    v_cvt_pk_bf16_f32 v154, -v215, v214
    v_cvt_pk_bf16_f32 v170, -v214, -v215
    v_cvt_pk_bf16_f32 v186, v215, -v214
    v_cos_f32 v214, v213
    v_sin_f32 v215, v213
    v_fmamk_f32 v213, v212, 0x41500000, v213
    v_cvt_pk_bf16_f32 v139, v214, v215
    v_cvt_pk_bf16_f32 v155, -v215, v214
    v_cvt_pk_bf16_f32 v171, v215, -v214
    v_cvt_pk_bf16_f32 v187, v214, v215
    v_cos_f32 v214, v213
    v_sin_f32 v215, v213
    v_add_f32 v213, v213, v212
    v_cvt_pk_bf16_f32 v140, v214, v215
    v_cvt_pk_bf16_f32 v156, -v215, v214
    v_cvt_pk_bf16_f32 v172, v214, v215
    v_cvt_pk_bf16_f32 v188, -v215, v214
    v_cos_f32 v214, v213
    v_sin_f32 v215, v213
    v_add_f32 v213, v213, v212
    v_cvt_pk_bf16_f32 v141, v214, v215
    v_cvt_pk_bf16_f32 v157, -v215, v214
    v_cvt_pk_bf16_f32 v173, -v215, v214
    v_cvt_pk_bf16_f32 v189, -v214, -v215
    v_cos_f32 v214, v213
    v_sin_f32 v215, v213
    v_add_f32 v213, v213, v212
    v_cvt_pk_bf16_f32 v142, v214, v215
    v_cvt_pk_bf16_f32 v158, -v215, v214
    v_cvt_pk_bf16_f32 v174, -v214, -v215
    v_cvt_pk_bf16_f32 v190, v215, -v214
    v_cos_f32 v214, v213
    v_sin_f32 v215, v213
    s_nop 0
    v_cvt_pk_bf16_f32 v143, v214, v215
    v_cvt_pk_bf16_f32 v159, -v215, v214
    v_cvt_pk_bf16_f32 v175, v215, -v214
    v_cvt_pk_bf16_f32 v191, v214, v215
    s_and_b32 s52, s44, 1
    s_lshl_b32 s52, s52, 10
    s_add_u32 s52, s52, s62
    s_mul_i32 s52, s52, 514
    s_lshl_b32 s53, s48, 5
    s_add_u32 s63, s52, s53
    s_mul_i32 s53, s48, 32896
    s_add_u32 s52, s52, s53
    v_lshrrev_b32 v228, 5, v0
    v_mul_u32_u24 v228, 15936, v228
    v_lshl_add_u32 v228, v0, 4, v228
    v_add3_u32 v228, v228, s52, 8
    v_mul_u32_u24 v220, 65792, v2
    v_lshl_add_u32 v220, v1, 1, v220
    v_mov_b32 v240, 0
    v_mov_b32 v241, 0
    v_mov_b32 v242, 0
    v_mov_b32 v243, 0
    v_mov_b32 v244, 0
    v_mov_b32 v245, 0
    v_mov_b32 v246, 0
    v_mov_b32 v247, 0
    v_mov_b32 v248, 0
    v_mov_b32 v249, 0
    v_mov_b32 v250, 0
    v_mov_b32 v251, 0
    v_mov_b32 v252, 0
    v_mov_b32 v253, 0
    v_mov_b32 v254, 0
    v_mov_b32 v255, 0
    s_lshl2_add_u32 s52, s46, s44
    s_lshl_b32 s52, s52, 7
    s_add_u32 s52, s52, s45
    s_lshl_b32 s52, s52, 8
    s_add_u32 s52, s52, 8388608
    v_lshlrev_b32 v221, 12, v2
    v_lshl_add_u32 v221, v1, 4, v221
    v_add_u32 v221, s52, v221
    v_add_u32 v222, 16384, v221
    v_mov_b32 v224, -1
    v_mov_b32 v225, -1
    v_mov_b32 v226, -1
    v_mov_b32 v227, -1
    s_or_b32 s52, s2, s44
    v_add_u32 v53, s52, v0
    v_lshlrev_b32 v53, 8, v53
    v_mov_b32 v55, 1
    s_add_u32 m0, s66, 0
    s_nop 0
    buffer_load_dwordx4 v5, s[16:19], s83 offen offset:0 lds
    buffer_load_dwordx4 v6, s[16:19], s83 offen offset:1024 lds
    buffer_load_dwordx4 v7, s[16:19], s83 offen offset:2048 lds
    buffer_load_dwordx4 v8, s[16:19], s83 offen offset:3072 lds
    s_waitcnt vmcnt(15)
    s_waitcnt vmcnt(8)
    s_waitcnt lgkmcnt(0)
    ds_read_b128 a[96:99], v44 offset:18432
    ds_read_b128 a[100:103], v44 offset:20480
    ds_read_b128 a[104:107], v45 offset:18432
    ds_read_b128 a[108:111], v45 offset:20480
    ds_read_b64_tr_b16 a[128:129], v12 offset:26624
    ds_read_b64_tr_b16 a[130:131], v12 offset:28416
    ds_read_b64_tr_b16 a[132:133], v12 offset:26656
    ds_read_b64_tr_b16 a[134:135], v12 offset:28448
    ds_read_b64_tr_b16 a[136:137], v12 offset:26688
    ds_read_b64_tr_b16 a[138:139], v12 offset:28480
    ds_read_b64_tr_b16 a[140:141], v12 offset:26720
    ds_read_b64_tr_b16 a[142:143], v12 offset:28512
    ds_read_b64_tr_b16 a[144:145], v12 offset:26752
    ds_read_b64_tr_b16 a[146:147], v12 offset:28544
    ds_read_b64_tr_b16 a[148:149], v12 offset:26784
    ds_read_b64_tr_b16 a[150:151], v12 offset:28576
    ds_read_b64_tr_b16 a[152:153], v12 offset:26816
    ds_read_b64_tr_b16 a[154:155], v12 offset:28608
    ds_read_b128 a[156:159], v16 offset:0
    ds_read_b128 a[160:163], v16 offset:1024
    s_waitcnt lgkmcnt(14)
    v_mfma_f32_16x16x32_bf16 a[228:231], v[20:23], a[96:99], 0
    v_mfma_f32_16x16x32_bf16 a[236:239], a[96:99], a[96:99], 0
    v_mfma_f32_16x16x32_bf16 a[232:235], v[20:23], a[100:103], 0
    s_waitcnt lgkmcnt(0)
    s_barrier
    buffer_store_dword v55, v53, s[36:39], 0 offen sc1
    ds_read_b64_tr_b16 a[164:165], v13 offset:26624
    v_mfma_f32_16x16x32_bf16 a[240:243], a[100:103], a[100:103], 0
    ds_read_b64_tr_b16 a[166:167], v13 offset:28416
    v_mfma_f32_16x16x32_bf16 v[56:59], a[128:131], a[96:99], 0
    ds_read_b64_tr_b16 a[168:169], v13 offset:26656
    v_mfma_f32_16x16x32_bf16 v[60:63], a[128:131], a[100:103], 0
    s_add_u32 m0, s66, 4096
    s_nop 0
    buffer_load_dwordx4 v9, s[16:19], s83 offen offset:0 lds
    ds_read_b64_tr_b16 a[170:171], v13 offset:28448
    v_mfma_f32_16x16x32_bf16 a[200:203], v[20:23], a[128:131], 0
    ds_read_b64_tr_b16 a[172:173], v13 offset:26688
    v_mfma_f32_16x16x32_bf16 v[64:67], a[132:135], a[96:99], 0
    buffer_load_dwordx4 v10, s[16:19], s83 offen offset:1024 lds
    ds_read_b64_tr_b16 a[174:175], v13 offset:28480
    v_mfma_f32_16x16x32_bf16 v[68:71], a[132:135], a[100:103], 0
    ds_read_b64_tr_b16 a[176:177], v13 offset:26720
    v_mfma_f32_16x16x32_bf16 a[204:207], v[20:23], a[132:135], 0
    buffer_load_dwordx4 v11, s[16:19], s83 offen offset:2048 lds
    ds_read_b64_tr_b16 a[178:179], v13 offset:28512
    v_mfma_f32_16x16x32_bf16 v[72:75], a[136:139], a[96:99], 0
    ds_read_b64_tr_b16 a[180:181], v13 offset:26752
    v_mfma_f32_16x16x32_bf16 v[76:79], a[136:139], a[100:103], 0
    s_add_u32 m0, s66, 7168
    s_xor_b32 s57, s59, 256
    buffer_load_dwordx4 v40, s[4:7], s57 offen offset:0 lds
    ds_read_b64_tr_b16 a[182:183], v13 offset:28544
    v_mfma_f32_16x16x32_bf16 a[208:211], v[20:23], a[136:139], 0
    ds_read_b64_tr_b16 a[184:185], v13 offset:26784
    v_mfma_f32_16x16x32_bf16 v[80:83], a[140:143], a[96:99], 0
    buffer_load_dwordx4 v41, s[4:7], s57 offen offset:1024 lds
    ds_read_b64_tr_b16 a[186:187], v13 offset:28576
    v_mfma_f32_16x16x32_bf16 v[84:87], a[140:143], a[100:103], 0
    ds_read_b64_tr_b16 a[188:189], v13 offset:26816
    v_mfma_f32_16x16x32_bf16 a[212:215], v[20:23], a[140:143], 0
    buffer_load_dwordx4 v42, s[4:7], s57 offen offset:2048 lds
    ds_read_b64_tr_b16 a[190:191], v13 offset:28608
    v_mfma_f32_16x16x32_bf16 v[88:91], a[144:147], a[96:99], 0
    ds_read_b128 a[192:195], v17 offset:0
    v_mfma_f32_16x16x32_bf16 v[92:95], a[144:147], a[100:103], 0
    buffer_load_dwordx4 v43, s[4:7], s57 offen offset:3072 lds
    ds_read_b128 a[196:199], v17 offset:1024
    v_mfma_f32_16x16x32_bf16 a[216:219], v[20:23], a[144:147], 0
    v_mfma_f32_16x16x32_bf16 v[96:99], a[148:151], a[96:99], 0
    v_mfma_f32_16x16x32_bf16 v[100:103], a[148:151], a[100:103], 0
    v_mfma_f32_16x16x32_bf16 a[220:223], v[20:23], a[148:151], 0
    v_mfma_f32_16x16x32_bf16 v[104:107], a[152:155], a[96:99], 0
    v_mfma_f32_16x16x32_bf16 v[108:111], a[152:155], a[100:103], 0
    v_mfma_f32_16x16x32_bf16 a[224:227], v[20:23], a[152:155], 0
    v_mfma_f32_16x16x32_bf16 v[112:115], a[96:99], a[156:159], 0
    v_mfma_f32_16x16x32_bf16 v[116:119], a[100:103], a[156:159], 0
    v_mfma_f32_16x16x32_bf16 v[120:123], a[96:99], a[160:163], 0
    v_mfma_f32_16x16x32_bf16 v[124:127], a[100:103], a[160:163], 0
    v_mfma_f32_16x16x32_bf16 a[228:231], v[20:23], a[104:107], a[228:231]
    v_mfma_f32_16x16x32_bf16 a[236:239], a[104:107], a[104:107], a[236:239]
    v_mfma_f32_16x16x32_bf16 a[232:235], v[20:23], a[108:111], a[232:235]
    s_waitcnt lgkmcnt(0)
    s_waitcnt vmcnt(12)
    ds_read_b128 a[112:115], v44 offset:22528
    ds_read_b128 a[116:119], v44 offset:24576
    v_mfma_f32_16x16x32_bf16 a[240:243], a[108:111], a[108:111], a[240:243]
    ds_read_b128 a[120:123], v45 offset:22528
    ds_read_b128 a[124:127], v45 offset:24576
    v_mfma_f32_16x16x32_bf16 v[56:59], a[164:167], a[104:107], v[56:59]
    ds_read_b64_tr_b16 a[128:129], v14 offset:26624
    v_mfma_f32_16x16x32_bf16 v[60:63], a[164:167], a[108:111], v[60:63]
    ds_read_b64_tr_b16 a[130:131], v14 offset:28416
    v_mfma_f32_16x16x32_bf16 v[64:67], a[168:171], a[104:107], v[64:67]
    ds_read_b64_tr_b16 a[132:133], v14 offset:26656
    v_mfma_f32_16x16x32_bf16 v[68:71], a[168:171], a[108:111], v[68:71]
    s_add_u32 m0, s66, 18432
    s_xor_b32 s57, s59, 384
    buffer_load_dwordx4 v40, s[4:7], s57 offen offset:0 lds
    ds_read_b64_tr_b16 a[134:135], v14 offset:28448
    v_mfma_f32_16x16x32_bf16 v[72:75], a[172:175], a[104:107], v[72:75]
    ds_read_b64_tr_b16 a[136:137], v14 offset:26688
    v_mfma_f32_16x16x32_bf16 v[76:79], a[172:175], a[108:111], v[76:79]
    ds_read_b64_tr_b16 a[138:139], v14 offset:28480
    v_mfma_f32_16x16x32_bf16 v[80:83], a[176:179], a[104:107], v[80:83]
    ds_read_b64_tr_b16 a[140:141], v14 offset:26720
    v_mfma_f32_16x16x32_bf16 v[84:87], a[176:179], a[108:111], v[84:87]
    buffer_load_dwordx4 v41, s[4:7], s57 offen offset:1024 lds
    ds_read_b64_tr_b16 a[142:143], v14 offset:28512
    v_mfma_f32_16x16x32_bf16 v[88:91], a[180:183], a[104:107], v[88:91]
    ds_read_b64_tr_b16 a[144:145], v14 offset:26752
    v_mfma_f32_16x16x32_bf16 v[92:95], a[180:183], a[108:111], v[92:95]
    ds_read_b64_tr_b16 a[146:147], v14 offset:28544
    v_mfma_f32_16x16x32_bf16 v[96:99], a[184:187], a[104:107], v[96:99]
    ds_read_b64_tr_b16 a[148:149], v14 offset:26784
    v_mfma_f32_16x16x32_bf16 v[100:103], a[184:187], a[108:111], v[100:103]
    buffer_load_dwordx4 v42, s[4:7], s57 offen offset:2048 lds
    ds_read_b64_tr_b16 a[150:151], v14 offset:28576
    v_mfma_f32_16x16x32_bf16 v[104:107], a[188:191], a[104:107], v[104:107]
    ds_read_b64_tr_b16 a[152:153], v14 offset:26816
    v_mfma_f32_16x16x32_bf16 v[108:111], a[188:191], a[108:111], v[108:111]
    ds_read_b64_tr_b16 a[154:155], v14 offset:28608
    v_mfma_f32_16x16x32_bf16 v[112:115], a[104:107], a[192:195], v[112:115]
    ds_read_b128 a[156:159], v18 offset:0
    v_mfma_f32_16x16x32_bf16 v[116:119], a[108:111], a[192:195], v[116:119]
    buffer_load_dwordx4 v43, s[4:7], s57 offen offset:3072 lds
    ds_read_b128 a[160:163], v18 offset:1024
    v_mfma_f32_16x16x32_bf16 v[120:123], a[104:107], a[196:199], v[120:123]
    v_mfma_f32_16x16x32_bf16 v[124:127], a[108:111], a[196:199], v[124:127]
    s_waitcnt lgkmcnt(14)
    v_mfma_f32_16x16x32_bf16 a[228:231], v[20:23], a[112:115], a[228:231]
    v_mfma_f32_16x16x32_bf16 a[236:239], a[112:115], a[112:115], a[236:239]
    v_mfma_f32_16x16x32_bf16 a[232:235], v[20:23], a[116:119], a[232:235]
    s_waitcnt lgkmcnt(0)
    ds_read_b64_tr_b16 a[164:165], v15 offset:26624
    v_mfma_f32_16x16x32_bf16 a[240:243], a[116:119], a[116:119], a[240:243]
    ds_read_b64_tr_b16 a[166:167], v15 offset:28416
    v_mfma_f32_16x16x32_bf16 v[56:59], a[128:131], a[112:115], v[56:59]
    ds_read_b64_tr_b16 a[168:169], v15 offset:26656
    v_mfma_f32_16x16x32_bf16 v[60:63], a[128:131], a[116:119], v[60:63]
    ds_read_b64_tr_b16 a[170:171], v15 offset:28448
    v_mfma_f32_16x16x32_bf16 v[64:67], a[132:135], a[112:115], v[64:67]
    ds_read_b64_tr_b16 a[172:173], v15 offset:26688
    v_mfma_f32_16x16x32_bf16 v[68:71], a[132:135], a[116:119], v[68:71]
    s_add_u32 m0, s66, 11264
    s_nop 0
    buffer_load_dwordx4 v5, s[16:19], s84 offen offset:0 lds
    ds_read_b64_tr_b16 a[174:175], v15 offset:28480
    v_mfma_f32_16x16x32_bf16 v[72:75], a[136:139], a[112:115], v[72:75]
    ds_read_b64_tr_b16 a[176:177], v15 offset:26720
    v_mfma_f32_16x16x32_bf16 v[76:79], a[136:139], a[116:119], v[76:79]
    ds_read_b64_tr_b16 a[178:179], v15 offset:28512
    v_mfma_f32_16x16x32_bf16 v[80:83], a[140:143], a[112:115], v[80:83]
    ds_read_b64_tr_b16 a[180:181], v15 offset:26752
    v_mfma_f32_16x16x32_bf16 v[84:87], a[140:143], a[116:119], v[84:87]
    buffer_load_dwordx4 v6, s[16:19], s84 offen offset:1024 lds
    ds_read_b64_tr_b16 a[182:183], v15 offset:28544
    v_mfma_f32_16x16x32_bf16 v[88:91], a[144:147], a[112:115], v[88:91]
    ds_read_b64_tr_b16 a[184:185], v15 offset:26784
    v_mfma_f32_16x16x32_bf16 v[92:95], a[144:147], a[116:119], v[92:95]
    ds_read_b64_tr_b16 a[186:187], v15 offset:28576
    v_mfma_f32_16x16x32_bf16 v[96:99], a[148:151], a[112:115], v[96:99]
    ds_read_b64_tr_b16 a[188:189], v15 offset:26816
    v_mfma_f32_16x16x32_bf16 v[100:103], a[148:151], a[116:119], v[100:103]
    buffer_load_dwordx4 v7, s[16:19], s84 offen offset:2048 lds
    ds_read_b64_tr_b16 a[190:191], v15 offset:28608
    v_mfma_f32_16x16x32_bf16 v[104:107], a[152:155], a[112:115], v[104:107]
    ds_read_b128 a[192:195], v19 offset:0
    v_mfma_f32_16x16x32_bf16 v[108:111], a[152:155], a[116:119], v[108:111]
    ds_read_b128 a[196:199], v19 offset:1024
    v_mfma_f32_16x16x32_bf16 v[112:115], a[112:115], a[156:159], v[112:115]
    v_mfma_f32_16x16x32_bf16 v[116:119], a[116:119], a[156:159], v[116:119]
    buffer_load_dwordx4 v8, s[16:19], s84 offen offset:3072 lds
    v_mfma_f32_16x16x32_bf16 v[120:123], a[112:115], a[160:163], v[120:123]
    v_mfma_f32_16x16x32_bf16 v[124:127], a[116:119], a[160:163], v[124:127]
    v_mfma_f32_16x16x32_bf16 a[228:231], v[20:23], a[120:123], a[228:231]
    v_mfma_f32_16x16x32_bf16 a[236:239], a[120:123], a[120:123], a[236:239]
    v_mfma_f32_16x16x32_bf16 a[232:235], v[20:23], a[124:127], a[232:235]
    s_waitcnt lgkmcnt(0)
    s_waitcnt vmcnt(12)
    s_waitcnt vmcnt(8)
    ds_read_b128 a[96:99], v44 offset:7168
    ds_read_b128 a[100:103], v44 offset:9216
    v_mfma_f32_16x16x32_bf16 a[240:243], a[124:127], a[124:127], a[240:243]
    ds_read_b128 a[104:107], v45 offset:7168
    ds_read_b128 a[108:111], v45 offset:9216
    v_mfma_f32_16x16x32_bf16 v[56:59], a[164:167], a[120:123], v[56:59]
    ds_read_b64_tr_b16 a[128:129], v12 offset:0
    v_mfma_f32_16x16x32_bf16 v[60:63], a[164:167], a[124:127], v[60:63]
    s_add_u32 m0, s66, 15360
    s_nop 0
    buffer_load_dwordx4 v9, s[16:19], s84 offen offset:0 lds
    ds_read_b64_tr_b16 a[130:131], v12 offset:1792
    v_mfma_f32_16x16x32_bf16 v[64:67], a[168:171], a[120:123], v[64:67]
    ds_read_b64_tr_b16 a[132:133], v12 offset:32
    v_mfma_f32_16x16x32_bf16 v[68:71], a[168:171], a[124:127], v[68:71]
    buffer_load_dwordx4 v10, s[16:19], s84 offen offset:1024 lds
    ds_read_b64_tr_b16 a[134:135], v12 offset:1824
    v_mfma_f32_16x16x32_bf16 v[72:75], a[172:175], a[120:123], v[72:75]
    ds_read_b64_tr_b16 a[136:137], v12 offset:64
    v_mfma_f32_16x16x32_bf16 v[76:79], a[172:175], a[124:127], v[76:79]
    buffer_load_dwordx4 v11, s[16:19], s84 offen offset:2048 lds
    ds_read_b64_tr_b16 a[138:139], v12 offset:1856
    v_mfma_f32_16x16x32_bf16 v[80:83], a[176:179], a[120:123], v[80:83]
    ds_read_b64_tr_b16 a[140:141], v12 offset:96
    v_mfma_f32_16x16x32_bf16 v[84:87], a[176:179], a[124:127], v[84:87]
    s_add_u32 m0, s66, 22528
    s_xor_b32 s57, s59, 512
    buffer_load_dwordx4 v40, s[4:7], s57 offen offset:0 lds
    ds_read_b64_tr_b16 a[142:143], v12 offset:1888
    v_mfma_f32_16x16x32_bf16 v[88:91], a[180:183], a[120:123], v[88:91]
    ds_read_b64_tr_b16 a[144:145], v12 offset:128
    v_mfma_f32_16x16x32_bf16 v[92:95], a[180:183], a[124:127], v[92:95]
    buffer_load_dwordx4 v41, s[4:7], s57 offen offset:1024 lds
    ds_read_b64_tr_b16 a[146:147], v12 offset:1920
    v_mfma_f32_16x16x32_bf16 v[96:99], a[184:187], a[120:123], v[96:99]
    ds_read_b64_tr_b16 a[148:149], v12 offset:160
    v_mfma_f32_16x16x32_bf16 v[100:103], a[184:187], a[124:127], v[100:103]
    buffer_store_dwordx4 v[224:227], v221, s[40:43], 0 offen sc1
    ds_read_b64_tr_b16 a[150:151], v12 offset:1952
    v_mfma_f32_16x16x32_bf16 v[104:107], a[188:191], a[120:123], v[104:107]
    ds_read_b64_tr_b16 a[152:153], v12 offset:192
    v_mfma_f32_16x16x32_bf16 v[108:111], a[188:191], a[124:127], v[108:111]
    buffer_store_dwordx4 v[224:227], v222, s[40:43], 0 offen sc1
    ds_read_b64_tr_b16 a[154:155], v12 offset:1984
    v_mfma_f32_16x16x32_bf16 v[112:115], a[120:123], a[192:195], v[112:115]
    ds_read_b128 a[156:159], v16 offset:8192
    v_mfma_f32_16x16x32_bf16 v[116:119], a[124:127], a[192:195], v[116:119]
    ds_read_b128 a[160:163], v16 offset:9216
    v_mfma_f32_16x16x32_bf16 v[120:123], a[120:123], a[196:199], v[120:123]
    v_mfma_f32_16x16x32_bf16 v[124:127], a[124:127], a[196:199], v[124:127]
    s_waitcnt lgkmcnt(14)
    v_mfma_f32_16x16x32_bf16 a[228:231], v[20:23], a[96:99], a[228:231]
    v_mfma_f32_16x16x32_bf16 a[236:239], a[96:99], a[96:99], a[236:239]
    v_mfma_f32_16x16x32_bf16 a[232:235], v[20:23], a[100:103], a[232:235]
    s_waitcnt lgkmcnt(0)
    s_barrier
    ds_read_b64_tr_b16 a[164:165], v13 offset:0
    v_mfma_f32_16x16x32_bf16 a[240:243], a[100:103], a[100:103], a[240:243]
    ds_read_b64_tr_b16 a[166:167], v13 offset:1792
    v_mfma_f32_16x16x32_bf16 v[56:59], a[128:131], a[96:99], v[56:59]
    ds_read_b64_tr_b16 a[168:169], v13 offset:32
    v_mfma_f32_16x16x32_bf16 v[60:63], a[128:131], a[100:103], v[60:63]
    ds_read_b64_tr_b16 a[170:171], v13 offset:1824
    v_mfma_f32_16x16x32_bf16 a[200:203], v[20:23], a[128:131], a[200:203]
    buffer_load_dwordx4 v42, s[4:7], s57 offen offset:2048 lds
    ds_read_b64_tr_b16 a[172:173], v13 offset:64
    v_mfma_f32_16x16x32_bf16 v[64:67], a[132:135], a[96:99], v[64:67]
    ds_read_b64_tr_b16 a[174:175], v13 offset:1856
    v_mfma_f32_16x16x32_bf16 v[68:71], a[132:135], a[100:103], v[68:71]
    ds_read_b64_tr_b16 a[176:177], v13 offset:96
    v_mfma_f32_16x16x32_bf16 a[204:207], v[20:23], a[132:135], a[204:207]
    buffer_load_dwordx4 v43, s[4:7], s57 offen offset:3072 lds
    ds_read_b64_tr_b16 a[178:179], v13 offset:1888
    v_mfma_f32_16x16x32_bf16 v[72:75], a[136:139], a[96:99], v[72:75]
    ds_read_b64_tr_b16 a[180:181], v13 offset:128
    v_mfma_f32_16x16x32_bf16 v[76:79], a[136:139], a[100:103], v[76:79]
    ds_read_b64_tr_b16 a[182:183], v13 offset:1920
    v_mfma_f32_16x16x32_bf16 a[208:211], v[20:23], a[136:139], a[208:211]
    s_add_u32 m0, s66, 7168
    s_xor_b32 s57, s59, 640
    buffer_load_dwordx4 v40, s[4:7], s57 offen offset:0 lds
    ds_read_b64_tr_b16 a[184:185], v13 offset:160
    v_mfma_f32_16x16x32_bf16 v[80:83], a[140:143], a[96:99], v[80:83]
    ds_read_b64_tr_b16 a[186:187], v13 offset:1952
    v_mfma_f32_16x16x32_bf16 v[84:87], a[140:143], a[100:103], v[84:87]
    ds_read_b64_tr_b16 a[188:189], v13 offset:192
    v_mfma_f32_16x16x32_bf16 a[212:215], v[20:23], a[140:143], a[212:215]
    buffer_load_dwordx4 v41, s[4:7], s57 offen offset:1024 lds
    ds_read_b64_tr_b16 a[190:191], v13 offset:1984
    v_mfma_f32_16x16x32_bf16 v[88:91], a[144:147], a[96:99], v[88:91]
    ds_read_b128 a[192:195], v17 offset:8192
    v_mfma_f32_16x16x32_bf16 v[92:95], a[144:147], a[100:103], v[92:95]
    ds_read_b128 a[196:199], v17 offset:9216
    v_mfma_f32_16x16x32_bf16 a[216:219], v[20:23], a[144:147], a[216:219]
    buffer_load_dwordx4 v42, s[4:7], s57 offen offset:2048 lds
    v_mfma_f32_16x16x32_bf16 v[96:99], a[148:151], a[96:99], v[96:99]
    v_mfma_f32_16x16x32_bf16 v[100:103], a[148:151], a[100:103], v[100:103]
    v_mfma_f32_16x16x32_bf16 a[220:223], v[20:23], a[148:151], a[220:223]
    buffer_load_dwordx4 v43, s[4:7], s57 offen offset:3072 lds
    v_mfma_f32_16x16x32_bf16 v[104:107], a[152:155], a[96:99], v[104:107]
    v_mfma_f32_16x16x32_bf16 v[108:111], a[152:155], a[100:103], v[108:111]
    v_mfma_f32_16x16x32_bf16 a[224:227], v[20:23], a[152:155], a[224:227]
    v_mfma_f32_16x16x32_bf16 v[112:115], a[96:99], a[156:159], v[112:115]
    v_mfma_f32_16x16x32_bf16 v[116:119], a[100:103], a[156:159], v[116:119]
    v_mfma_f32_16x16x32_bf16 v[120:123], a[96:99], a[160:163], v[120:123]
    v_mfma_f32_16x16x32_bf16 v[124:127], a[100:103], a[160:163], v[124:127]
    v_mfma_f32_16x16x32_bf16 a[228:231], v[20:23], a[104:107], a[228:231]
    v_mfma_f32_16x16x32_bf16 a[236:239], a[104:107], a[104:107], a[236:239]
    v_mfma_f32_16x16x32_bf16 a[232:235], v[20:23], a[108:111], a[232:235]
    s_waitcnt lgkmcnt(0)
    s_waitcnt vmcnt(17)
    ds_read_b128 a[112:115], v44 offset:18432
    ds_read_b128 a[116:119], v44 offset:20480
    v_mfma_f32_16x16x32_bf16 a[240:243], a[108:111], a[108:111], a[240:243]
    ds_read_b128 a[120:123], v45 offset:18432
    ds_read_b128 a[124:127], v45 offset:20480
    v_mfma_f32_16x16x32_bf16 v[56:59], a[164:167], a[104:107], v[56:59]
    ds_read_b64_tr_b16 a[128:129], v14 offset:0
    v_mfma_f32_16x16x32_bf16 v[60:63], a[164:167], a[108:111], v[60:63]
    ds_read_b64_tr_b16 a[130:131], v14 offset:1792
    v_mfma_f32_16x16x32_bf16 v[64:67], a[168:171], a[104:107], v[64:67]
    ds_read_b64_tr_b16 a[132:133], v14 offset:32
    v_mfma_f32_16x16x32_bf16 v[68:71], a[168:171], a[108:111], v[68:71]
    s_add_u32 m0, s66, 26624
    s_nop 0
    buffer_load_dwordx4 v5, s[16:19], s85 offen offset:0 lds
    ds_read_b64_tr_b16 a[134:135], v14 offset:1824
    v_mfma_f32_16x16x32_bf16 v[72:75], a[172:175], a[104:107], v[72:75]
    ds_read_b64_tr_b16 a[136:137], v14 offset:64
    v_mfma_f32_16x16x32_bf16 v[76:79], a[172:175], a[108:111], v[76:79]
    ds_read_b64_tr_b16 a[138:139], v14 offset:1856
    v_mfma_f32_16x16x32_bf16 v[80:83], a[176:179], a[104:107], v[80:83]
    ds_read_b64_tr_b16 a[140:141], v14 offset:96
    v_mfma_f32_16x16x32_bf16 v[84:87], a[176:179], a[108:111], v[84:87]
    buffer_load_dwordx4 v6, s[16:19], s85 offen offset:1024 lds
    ds_read_b64_tr_b16 a[142:143], v14 offset:1888
    v_mfma_f32_16x16x32_bf16 v[88:91], a[180:183], a[104:107], v[88:91]
    ds_read_b64_tr_b16 a[144:145], v14 offset:128
    v_mfma_f32_16x16x32_bf16 v[92:95], a[180:183], a[108:111], v[92:95]
    ds_read_b64_tr_b16 a[146:147], v14 offset:1920
    v_mfma_f32_16x16x32_bf16 v[96:99], a[184:187], a[104:107], v[96:99]
    ds_read_b64_tr_b16 a[148:149], v14 offset:160
    v_mfma_f32_16x16x32_bf16 v[100:103], a[184:187], a[108:111], v[100:103]
    buffer_load_dwordx4 v7, s[16:19], s85 offen offset:2048 lds
    ds_read_b64_tr_b16 a[150:151], v14 offset:1952
    v_mfma_f32_16x16x32_bf16 v[104:107], a[188:191], a[104:107], v[104:107]
    ds_read_b64_tr_b16 a[152:153], v14 offset:192
    v_mfma_f32_16x16x32_bf16 v[108:111], a[188:191], a[108:111], v[108:111]
    ds_read_b64_tr_b16 a[154:155], v14 offset:1984
    v_mfma_f32_16x16x32_bf16 v[112:115], a[104:107], a[192:195], v[112:115]
    ds_read_b128 a[156:159], v18 offset:8192
    v_mfma_f32_16x16x32_bf16 v[116:119], a[108:111], a[192:195], v[116:119]
    buffer_load_dwordx4 v8, s[16:19], s85 offen offset:3072 lds
    ds_read_b128 a[160:163], v18 offset:9216
    v_mfma_f32_16x16x32_bf16 v[120:123], a[104:107], a[196:199], v[120:123]
    v_mfma_f32_16x16x32_bf16 v[124:127], a[108:111], a[196:199], v[124:127]
    s_waitcnt lgkmcnt(14)
    v_mfma_f32_16x16x32_bf16 a[228:231], v[20:23], a[112:115], a[228:231]
    v_mfma_f32_16x16x32_bf16 a[236:239], a[112:115], a[112:115], a[236:239]
    v_mfma_f32_16x16x32_bf16 a[232:235], v[20:23], a[116:119], a[232:235]
    s_waitcnt lgkmcnt(0)
    ds_read_b64_tr_b16 a[164:165], v15 offset:0
    v_mfma_f32_16x16x32_bf16 a[240:243], a[116:119], a[116:119], a[240:243]
    ds_read_b64_tr_b16 a[166:167], v15 offset:1792
    v_mfma_f32_16x16x32_bf16 v[56:59], a[128:131], a[112:115], v[56:59]
    ds_read_b64_tr_b16 a[168:169], v15 offset:32
    v_mfma_f32_16x16x32_bf16 v[60:63], a[128:131], a[116:119], v[60:63]
    ds_read_b64_tr_b16 a[170:171], v15 offset:1824
    v_mfma_f32_16x16x32_bf16 v[64:67], a[132:135], a[112:115], v[64:67]
    s_add_u32 m0, s66, 30720
    s_nop 0
    buffer_load_dwordx4 v9, s[16:19], s85 offen offset:0 lds
    ds_read_b64_tr_b16 a[172:173], v15 offset:64
    v_mfma_f32_16x16x32_bf16 v[68:71], a[132:135], a[116:119], v[68:71]
    ds_read_b64_tr_b16 a[174:175], v15 offset:1856
    v_mfma_f32_16x16x32_bf16 v[72:75], a[136:139], a[112:115], v[72:75]
    ds_read_b64_tr_b16 a[176:177], v15 offset:96
    v_mfma_f32_16x16x32_bf16 v[76:79], a[136:139], a[116:119], v[76:79]
    buffer_load_dwordx4 v10, s[16:19], s85 offen offset:1024 lds
    ds_read_b64_tr_b16 a[178:179], v15 offset:1888
    v_mfma_f32_16x16x32_bf16 v[80:83], a[140:143], a[112:115], v[80:83]
    ds_read_b64_tr_b16 a[180:181], v15 offset:128
    v_mfma_f32_16x16x32_bf16 v[84:87], a[140:143], a[116:119], v[84:87]
    ds_read_b64_tr_b16 a[182:183], v15 offset:1920
    v_mfma_f32_16x16x32_bf16 v[88:91], a[144:147], a[112:115], v[88:91]
    buffer_load_dwordx4 v11, s[16:19], s85 offen offset:2048 lds
    ds_read_b64_tr_b16 a[184:185], v15 offset:160
    v_mfma_f32_16x16x32_bf16 v[92:95], a[144:147], a[116:119], v[92:95]
    ds_read_b64_tr_b16 a[186:187], v15 offset:1952
    v_mfma_f32_16x16x32_bf16 v[96:99], a[148:151], a[112:115], v[96:99]
    ds_read_b64_tr_b16 a[188:189], v15 offset:192
    v_mfma_f32_16x16x32_bf16 v[100:103], a[148:151], a[116:119], v[100:103]
    s_mul_i32 s58, s46, 224
    v_lshlrev_b32 v54, 3, v0
    buffer_load_dwordx2 v[46:47], v54, s[20:23], s58 offen
    ds_read_b64_tr_b16 a[190:191], v15 offset:1984
    v_mfma_f32_16x16x32_bf16 v[104:107], a[152:155], a[112:115], v[104:107]
    ds_read_b128 a[192:195], v19 offset:8192
    v_mfma_f32_16x16x32_bf16 v[108:111], a[152:155], a[116:119], v[108:111]
    ds_read_b128 a[196:199], v19 offset:9216
    v_mfma_f32_16x16x32_bf16 v[112:115], a[112:115], a[156:159], v[112:115]
    buffer_load_ushort v229, v228, s[8:11], 0 offen
    buffer_load_ushort v230, v228, s[12:15], 0 offen
    v_mfma_f32_16x16x32_bf16 v[116:119], a[116:119], a[156:159], v[116:119]
    v_mfma_f32_16x16x32_bf16 v[120:123], a[112:115], a[160:163], v[120:123]
    v_mfma_f32_16x16x32_bf16 v[124:127], a[116:119], a[160:163], v[124:127]
    v_mfma_f32_16x16x32_bf16 a[228:231], v[20:23], a[120:123], a[228:231]
    v_mfma_f32_16x16x32_bf16 a[236:239], a[120:123], a[120:123], a[236:239]
    v_mfma_f32_16x16x32_bf16 a[232:235], v[20:23], a[124:127], a[232:235]
    s_waitcnt lgkmcnt(0)
    s_waitcnt vmcnt(20)
    s_waitcnt vmcnt(14)
    ds_read_b128 a[96:99], v44 offset:22528
    ds_read_b128 a[100:103], v44 offset:24576
    v_mfma_f32_16x16x32_bf16 a[240:243], a[124:127], a[124:127], a[240:243]
    ds_read_b128 a[104:107], v45 offset:22528
    ds_read_b128 a[108:111], v45 offset:24576
    v_mfma_f32_16x16x32_bf16 v[56:59], a[164:167], a[120:123], v[56:59]
    ds_read_b64_tr_b16 a[128:129], v12 offset:11264
    v_mfma_f32_16x16x32_bf16 v[60:63], a[164:167], a[124:127], v[60:63]
    ds_read_b64_tr_b16 a[130:131], v12 offset:13056
    v_mfma_f32_16x16x32_bf16 v[64:67], a[168:171], a[120:123], v[64:67]
    ds_read_b64_tr_b16 a[132:133], v12 offset:11296
    v_mfma_f32_16x16x32_bf16 v[68:71], a[168:171], a[124:127], v[68:71]
    s_add_u32 m0, s66, 18432
    s_xor_b32 s57, s59, 768
    buffer_load_dwordx4 v40, s[4:7], s57 offen offset:0 lds
    ds_read_b64_tr_b16 a[134:135], v12 offset:13088
    v_mfma_f32_16x16x32_bf16 v[72:75], a[172:175], a[120:123], v[72:75]
    ds_read_b64_tr_b16 a[136:137], v12 offset:11328
    v_mfma_f32_16x16x32_bf16 v[76:79], a[172:175], a[124:127], v[76:79]
    ds_read_b64_tr_b16 a[138:139], v12 offset:13120
    v_mfma_f32_16x16x32_bf16 v[80:83], a[176:179], a[120:123], v[80:83]
    ds_read_b64_tr_b16 a[140:141], v12 offset:11360
    v_mfma_f32_16x16x32_bf16 v[84:87], a[176:179], a[124:127], v[84:87]
    buffer_load_dwordx4 v41, s[4:7], s57 offen offset:1024 lds
    ds_read_b64_tr_b16 a[142:143], v12 offset:13152
    v_mfma_f32_16x16x32_bf16 v[88:91], a[180:183], a[120:123], v[88:91]
    ds_read_b64_tr_b16 a[144:145], v12 offset:11392
    v_mfma_f32_16x16x32_bf16 v[92:95], a[180:183], a[124:127], v[92:95]
    ds_read_b64_tr_b16 a[146:147], v12 offset:13184
    v_mfma_f32_16x16x32_bf16 v[96:99], a[184:187], a[120:123], v[96:99]
    ds_read_b64_tr_b16 a[148:149], v12 offset:11424
    v_mfma_f32_16x16x32_bf16 v[100:103], a[184:187], a[124:127], v[100:103]
    buffer_load_dwordx4 v42, s[4:7], s57 offen offset:2048 lds
    ds_read_b64_tr_b16 a[150:151], v12 offset:13216
    v_mfma_f32_16x16x32_bf16 v[104:107], a[188:191], a[120:123], v[104:107]
    ds_read_b64_tr_b16 a[152:153], v12 offset:11456
    v_mfma_f32_16x16x32_bf16 v[108:111], a[188:191], a[124:127], v[108:111]
    ds_read_b64_tr_b16 a[154:155], v12 offset:13248
    v_mfma_f32_16x16x32_bf16 v[112:115], a[120:123], a[192:195], v[112:115]
    ds_read_b128 a[156:159], v16 offset:0
    v_mfma_f32_16x16x32_bf16 v[116:119], a[124:127], a[192:195], v[116:119]
    buffer_load_dwordx4 v43, s[4:7], s57 offen offset:3072 lds
    ds_read_b128 a[160:163], v16 offset:1024
    v_mfma_f32_16x16x32_bf16 v[120:123], a[120:123], a[196:199], v[120:123]
    v_mfma_f32_16x16x32_bf16 v[124:127], a[124:127], a[196:199], v[124:127]
    s_waitcnt lgkmcnt(14)
    v_mfma_f32_16x16x32_bf16 a[228:231], v[20:23], a[96:99], a[228:231]
    v_mfma_f32_16x16x32_bf16 a[236:239], a[96:99], a[96:99], a[236:239]
    v_mfma_f32_16x16x32_bf16 a[232:235], v[20:23], a[100:103], a[232:235]
    s_waitcnt lgkmcnt(0)
    s_barrier
    ds_read_b64_tr_b16 a[164:165], v13 offset:11264
    v_mfma_f32_16x16x32_bf16 a[240:243], a[100:103], a[100:103], a[240:243]
    v_mul_f32 v112, v48, v112
    ds_read_b64_tr_b16 a[166:167], v13 offset:13056
    v_mfma_f32_16x16x32_bf16 v[56:59], a[128:131], a[96:99], v[56:59]
    v_mul_f32 v113, v48, v113
    ds_read_b64_tr_b16 a[168:169], v13 offset:11296
    v_mfma_f32_16x16x32_bf16 v[60:63], a[128:131], a[100:103], v[60:63]
    v_mul_f32 v114, v48, v114
    ds_read_b64_tr_b16 a[170:171], v13 offset:13088
    v_mfma_f32_16x16x32_bf16 a[200:203], v[20:23], a[128:131], a[200:203]
    s_add_u32 m0, s66, 22528
    s_xor_b32 s57, s59, 896
    buffer_load_dwordx4 v40, s[4:7], s57 offen offset:0 lds
    v_mul_f32 v115, v48, v115
    ds_read_b64_tr_b16 a[172:173], v13 offset:11328
    v_mfma_f32_16x16x32_bf16 v[64:67], a[132:135], a[96:99], v[64:67]
    v_mul_f32 v116, v48, v116
    ds_read_b64_tr_b16 a[174:175], v13 offset:13120
    v_mfma_f32_16x16x32_bf16 v[68:71], a[132:135], a[100:103], v[68:71]
    v_mul_f32 v117, v48, v117
    ds_read_b64_tr_b16 a[176:177], v13 offset:11360
    v_mfma_f32_16x16x32_bf16 a[204:207], v[20:23], a[132:135], a[204:207]
    buffer_load_dwordx4 v41, s[4:7], s57 offen offset:1024 lds
    v_mul_f32 v118, v48, v118
    ds_read_b64_tr_b16 a[178:179], v13 offset:13152
    v_mfma_f32_16x16x32_bf16 v[72:75], a[136:139], a[96:99], v[72:75]
    v_mul_f32 v119, v48, v119
    ds_read_b64_tr_b16 a[180:181], v13 offset:11392
    v_mfma_f32_16x16x32_bf16 v[76:79], a[136:139], a[100:103], v[76:79]
    v_mul_f32 v120, v48, v120
    ds_read_b64_tr_b16 a[182:183], v13 offset:13184
    v_mfma_f32_16x16x32_bf16 a[208:211], v[20:23], a[136:139], a[208:211]
    buffer_load_dwordx4 v42, s[4:7], s57 offen offset:2048 lds
    v_mul_f32 v121, v48, v121
    ds_read_b64_tr_b16 a[184:185], v13 offset:11424
    v_mfma_f32_16x16x32_bf16 v[80:83], a[140:143], a[96:99], v[80:83]
    v_mul_f32 v122, v48, v122
    ds_read_b64_tr_b16 a[186:187], v13 offset:13216
    v_mfma_f32_16x16x32_bf16 v[84:87], a[140:143], a[100:103], v[84:87]
    v_mul_f32 v123, v48, v123
    ds_read_b64_tr_b16 a[188:189], v13 offset:11456
    v_mfma_f32_16x16x32_bf16 a[212:215], v[20:23], a[140:143], a[212:215]
    buffer_load_dwordx4 v43, s[4:7], s57 offen offset:3072 lds
    v_mul_f32 v124, v48, v124
    ds_read_b64_tr_b16 a[190:191], v13 offset:13248
    v_mfma_f32_16x16x32_bf16 v[88:91], a[144:147], a[96:99], v[88:91]
    v_mul_f32 v125, v48, v125
    ds_read_b128 a[192:195], v17 offset:0
    v_mfma_f32_16x16x32_bf16 v[92:95], a[144:147], a[100:103], v[92:95]
    v_mul_f32 v126, v48, v126
    ds_read_b128 a[196:199], v17 offset:1024
    v_mfma_f32_16x16x32_bf16 a[216:219], v[20:23], a[144:147], a[216:219]
    v_mov_b32 v6, 0
    v_mov_b32 v8, 1
    v_min_u32 v5, 1, v0
    v_lshlrev_b32 v5, 28, v5
    buffer_load_dword v7, v6, s[36:39], 0 offen sc1
    v_mul_f32 v127, v48, v127
    v_mfma_f32_16x16x32_bf16 v[96:99], a[148:151], a[96:99], v[96:99]
    v_mfma_f32_16x16x32_bf16 v[100:103], a[148:151], a[100:103], v[100:103]
    v_mfma_f32_16x16x32_bf16 a[220:223], v[20:23], a[148:151], a[220:223]
    v_mfma_f32_16x16x32_bf16 v[104:107], a[152:155], a[96:99], v[104:107]
    v_mfma_f32_16x16x32_bf16 v[108:111], a[152:155], a[100:103], v[108:111]
    v_mfma_f32_16x16x32_bf16 a[224:227], v[20:23], a[152:155], a[224:227]
    v_mfma_f32_16x16x32_bf16 v[112:115], a[96:99], a[156:159], v[112:115]
    v_mfma_f32_16x16x32_bf16 v[116:119], a[100:103], a[156:159], v[116:119]
    v_mfma_f32_16x16x32_bf16 v[120:123], a[96:99], a[160:163], v[120:123]
    v_mfma_f32_16x16x32_bf16 v[124:127], a[100:103], a[160:163], v[124:127]
    v_mfma_f32_16x16x32_bf16 a[228:231], v[20:23], a[104:107], a[228:231]
    v_mfma_f32_16x16x32_bf16 a[236:239], a[104:107], a[104:107], a[236:239]
    v_mfma_f32_16x16x32_bf16 a[232:235], v[20:23], a[108:111], a[232:235]
    s_waitcnt lgkmcnt(0)
    s_waitcnt vmcnt(19)
    ds_read_b128 a[112:115], v44 offset:7168
    ds_read_b128 a[116:119], v44 offset:9216
    v_mfma_f32_16x16x32_bf16 a[240:243], a[108:111], a[108:111], a[240:243]
    ds_read_b128 a[120:123], v45 offset:7168
    ds_read_b128 a[124:127], v45 offset:9216
    v_mfma_f32_16x16x32_bf16 v[56:59], a[164:167], a[104:107], v[56:59]
    ds_read_b64_tr_b16 a[128:129], v14 offset:11264
    v_mfma_f32_16x16x32_bf16 v[60:63], a[164:167], a[108:111], v[60:63]
    ds_read_b64_tr_b16 a[130:131], v14 offset:13056
    v_mfma_f32_16x16x32_bf16 v[64:67], a[168:171], a[104:107], v[64:67]
    ds_read_b64_tr_b16 a[132:133], v14 offset:11296
    v_mfma_f32_16x16x32_bf16 v[68:71], a[168:171], a[108:111], v[68:71]
    s_add_u32 s67, s65, 0
    s_cmp_ge_u32 s67, 28672
    s_cselect_b32 s53, 28672, 0
    s_sub_u32 s67, s67, s53
    s_lshl_b32 s67, s67, 4
    s_add_u32 m0, s66, 0
    s_nop 0
    buffer_load_dwordx4 v49, s[24:27], s67 offen offset:0 lds
    ds_read_b64_tr_b16 a[134:135], v14 offset:13088
    v_mfma_f32_16x16x32_bf16 v[72:75], a[172:175], a[104:107], v[72:75]
    ds_read_b64_tr_b16 a[136:137], v14 offset:11328
    v_mfma_f32_16x16x32_bf16 v[76:79], a[172:175], a[108:111], v[76:79]
    ds_read_b64_tr_b16 a[138:139], v14 offset:13120
    v_mfma_f32_16x16x32_bf16 v[80:83], a[176:179], a[104:107], v[80:83]
    ds_read_b64_tr_b16 a[140:141], v14 offset:11360
    v_mfma_f32_16x16x32_bf16 v[84:87], a[176:179], a[108:111], v[84:87]
    buffer_load_dwordx4 v50, s[24:27], s67 offen offset:1024 lds
    ds_read_b64_tr_b16 a[142:143], v14 offset:13152
    v_mfma_f32_16x16x32_bf16 v[88:91], a[180:183], a[104:107], v[88:91]
    ds_read_b64_tr_b16 a[144:145], v14 offset:11392
    v_mfma_f32_16x16x32_bf16 v[92:95], a[180:183], a[108:111], v[92:95]
    ds_read_b64_tr_b16 a[146:147], v14 offset:13184
    v_mfma_f32_16x16x32_bf16 v[96:99], a[184:187], a[104:107], v[96:99]
    ds_read_b64_tr_b16 a[148:149], v14 offset:11424
    v_mfma_f32_16x16x32_bf16 v[100:103], a[184:187], a[108:111], v[100:103]
    buffer_load_dwordx4 v51, s[24:27], s67 offen offset:2048 lds
    ds_read_b64_tr_b16 a[150:151], v14 offset:13216
    v_mfma_f32_16x16x32_bf16 v[104:107], a[188:191], a[104:107], v[104:107]
    ds_read_b64_tr_b16 a[152:153], v14 offset:11456
    v_mfma_f32_16x16x32_bf16 v[108:111], a[188:191], a[108:111], v[108:111]
    ds_read_b64_tr_b16 a[154:155], v14 offset:13248
    v_mfma_f32_16x16x32_bf16 v[112:115], a[104:107], a[192:195], v[112:115]
    ds_read_b128 a[156:159], v18 offset:0
    v_mfma_f32_16x16x32_bf16 v[116:119], a[108:111], a[192:195], v[116:119]
    buffer_load_dwordx4 v52, s[24:27], s67 offen offset:3072 lds
    ds_read_b128 a[160:163], v18 offset:1024
    v_mfma_f32_16x16x32_bf16 v[120:123], a[104:107], a[196:199], v[120:123]
    v_mfma_f32_16x16x32_bf16 v[124:127], a[108:111], a[196:199], v[124:127]
    s_waitcnt lgkmcnt(14)
    v_mfma_f32_16x16x32_bf16 a[228:231], v[20:23], a[112:115], a[228:231]
    v_mfma_f32_16x16x32_bf16 a[236:239], a[112:115], a[112:115], a[236:239]
    v_mfma_f32_16x16x32_bf16 a[232:235], v[20:23], a[116:119], a[232:235]
    s_waitcnt lgkmcnt(0)
    ds_read_b64_tr_b16 a[164:165], v15 offset:11264
    v_mfma_f32_16x16x32_bf16 a[240:243], a[116:119], a[116:119], a[240:243]
    ds_read_b64_tr_b16 a[166:167], v15 offset:13056
    v_mfma_f32_16x16x32_bf16 v[56:59], a[128:131], a[112:115], v[56:59]
    ds_read_b64_tr_b16 a[168:169], v15 offset:11296
    v_mfma_f32_16x16x32_bf16 v[60:63], a[128:131], a[116:119], v[60:63]
    ds_read_b64_tr_b16 a[170:171], v15 offset:13088
    v_mfma_f32_16x16x32_bf16 v[64:67], a[132:135], a[112:115], v[64:67]
    ds_read_b64_tr_b16 a[172:173], v15 offset:11328
    v_mfma_f32_16x16x32_bf16 v[68:71], a[132:135], a[116:119], v[68:71]
    ds_read_b64_tr_b16 a[174:175], v15 offset:13120
    v_mfma_f32_16x16x32_bf16 v[72:75], a[136:139], a[112:115], v[72:75]
    ds_read_b64_tr_b16 a[176:177], v15 offset:11360
    v_mfma_f32_16x16x32_bf16 v[76:79], a[136:139], a[116:119], v[76:79]
    ds_read_b64_tr_b16 a[178:179], v15 offset:13152
    v_mfma_f32_16x16x32_bf16 v[80:83], a[140:143], a[112:115], v[80:83]
    ds_read_b64_tr_b16 a[180:181], v15 offset:11392
    v_mfma_f32_16x16x32_bf16 v[84:87], a[140:143], a[116:119], v[84:87]
    ds_read_b64_tr_b16 a[182:183], v15 offset:13184
    v_mfma_f32_16x16x32_bf16 v[88:91], a[144:147], a[112:115], v[88:91]
    ds_read_b64_tr_b16 a[184:185], v15 offset:11424
    v_mfma_f32_16x16x32_bf16 v[92:95], a[144:147], a[116:119], v[92:95]
    ds_read_b64_tr_b16 a[186:187], v15 offset:13216
    v_mfma_f32_16x16x32_bf16 v[96:99], a[148:151], a[112:115], v[96:99]
    ds_read_b64_tr_b16 a[188:189], v15 offset:11456
    v_mfma_f32_16x16x32_bf16 v[100:103], a[148:151], a[116:119], v[100:103]
    ds_read_b64_tr_b16 a[190:191], v15 offset:13248
    v_mfma_f32_16x16x32_bf16 v[104:107], a[152:155], a[112:115], v[104:107]
    ds_read_b128 a[192:195], v19 offset:0
    v_mfma_f32_16x16x32_bf16 v[108:111], a[152:155], a[116:119], v[108:111]
    ds_read_b128 a[196:199], v19 offset:1024
    v_mfma_f32_16x16x32_bf16 v[112:115], a[112:115], a[156:159], v[112:115]
    v_mfma_f32_16x16x32_bf16 v[116:119], a[116:119], a[156:159], v[116:119]
    v_mfma_f32_16x16x32_bf16 v[120:123], a[112:115], a[160:163], v[120:123]
    v_mfma_f32_16x16x32_bf16 v[124:127], a[116:119], a[160:163], v[124:127]
    v_mfma_f32_16x16x32_bf16 a[228:231], v[20:23], a[120:123], a[228:231]
    v_mfma_f32_16x16x32_bf16 a[236:239], a[120:123], a[120:123], a[236:239]
    v_mfma_f32_16x16x32_bf16 a[232:235], v[20:23], a[124:127], a[232:235]
    s_waitcnt lgkmcnt(0)
    s_waitcnt vmcnt(16)
    s_waitcnt vmcnt(9)
    ds_read_b128 a[96:99], v44 offset:18432
    ds_read_b128 a[100:103], v44 offset:20480
    v_mfma_f32_16x16x32_bf16 a[240:243], a[124:127], a[124:127], a[240:243]
    ds_read_b128 a[104:107], v45 offset:18432
    ds_read_b128 a[108:111], v45 offset:20480
    v_mfma_f32_16x16x32_bf16 v[56:59], a[164:167], a[120:123], v[56:59]
    ds_read_b64_tr_b16 a[128:129], v12 offset:26624
    v_mfma_f32_16x16x32_bf16 v[60:63], a[164:167], a[124:127], v[60:63]
    ds_read_b64_tr_b16 a[130:131], v12 offset:28416
    v_mfma_f32_16x16x32_bf16 v[64:67], a[168:171], a[120:123], v[64:67]
    ds_read_b64_tr_b16 a[132:133], v12 offset:26656
    v_mfma_f32_16x16x32_bf16 v[68:71], a[168:171], a[124:127], v[68:71]
    s_add_u32 s67, s65, 2048
    s_cmp_ge_u32 s67, 28672
    s_cselect_b32 s53, 28672, 0
    s_sub_u32 s67, s67, s53
    s_lshl_b32 s67, s67, 4
    s_add_u32 m0, s66, 4096
    s_nop 0
    buffer_load_dwordx4 v49, s[24:27], s67 offen offset:0 lds
    ds_read_b64_tr_b16 a[134:135], v12 offset:28448
    v_mfma_f32_16x16x32_bf16 v[72:75], a[172:175], a[120:123], v[72:75]
    ds_read_b64_tr_b16 a[136:137], v12 offset:26688
    v_mfma_f32_16x16x32_bf16 v[76:79], a[172:175], a[124:127], v[76:79]
    ds_read_b64_tr_b16 a[138:139], v12 offset:28480
    v_mfma_f32_16x16x32_bf16 v[80:83], a[176:179], a[120:123], v[80:83]
    ds_read_b64_tr_b16 a[140:141], v12 offset:26720
    v_mfma_f32_16x16x32_bf16 v[84:87], a[176:179], a[124:127], v[84:87]
    buffer_load_dwordx4 v50, s[24:27], s67 offen offset:1024 lds
    ds_read_b64_tr_b16 a[142:143], v12 offset:28512
    v_mfma_f32_16x16x32_bf16 v[88:91], a[180:183], a[120:123], v[88:91]
    ds_read_b64_tr_b16 a[144:145], v12 offset:26752
    v_mfma_f32_16x16x32_bf16 v[92:95], a[180:183], a[124:127], v[92:95]
    ds_read_b64_tr_b16 a[146:147], v12 offset:28544
    v_mfma_f32_16x16x32_bf16 v[96:99], a[184:187], a[120:123], v[96:99]
    ds_read_b64_tr_b16 a[148:149], v12 offset:26784
    v_mfma_f32_16x16x32_bf16 v[100:103], a[184:187], a[124:127], v[100:103]
    buffer_load_dwordx4 v51, s[24:27], s67 offen offset:2048 lds
    ds_read_b64_tr_b16 a[150:151], v12 offset:28576
    v_mfma_f32_16x16x32_bf16 v[104:107], a[188:191], a[120:123], v[104:107]
    ds_read_b64_tr_b16 a[152:153], v12 offset:26816
    v_mfma_f32_16x16x32_bf16 v[108:111], a[188:191], a[124:127], v[108:111]
    ds_read_b64_tr_b16 a[154:155], v12 offset:28608
    v_mfma_f32_16x16x32_bf16 v[112:115], a[120:123], a[192:195], v[112:115]
    ds_read_b128 a[156:159], v16 offset:8192
    v_mfma_f32_16x16x32_bf16 v[116:119], a[124:127], a[192:195], v[116:119]
    buffer_load_dwordx4 v52, s[24:27], s67 offen offset:3072 lds
    ds_read_b128 a[160:163], v16 offset:9216
    v_mfma_f32_16x16x32_bf16 v[120:123], a[120:123], a[196:199], v[120:123]
    v_mfma_f32_16x16x32_bf16 v[124:127], a[124:127], a[196:199], v[124:127]
    s_waitcnt lgkmcnt(14)
    v_mfma_f32_16x16x32_bf16 a[228:231], v[20:23], a[96:99], a[228:231]
    v_mfma_f32_16x16x32_bf16 a[236:239], a[96:99], a[96:99], a[236:239]
    v_mfma_f32_16x16x32_bf16 a[232:235], v[20:23], a[100:103], a[232:235]
    s_waitcnt lgkmcnt(0)
    s_barrier
    ds_read_b64_tr_b16 a[164:165], v13 offset:26624
    v_mfma_f32_16x16x32_bf16 a[240:243], a[100:103], a[100:103], a[240:243]
    ds_read_b64_tr_b16 a[166:167], v13 offset:28416
    v_mfma_f32_16x16x32_bf16 v[56:59], a[128:131], a[96:99], v[56:59]
    ds_read_b64_tr_b16 a[168:169], v13 offset:26656
    v_mfma_f32_16x16x32_bf16 v[60:63], a[128:131], a[100:103], v[60:63]
    ds_read_b64_tr_b16 a[170:171], v13 offset:28448
    v_mfma_f32_16x16x32_bf16 a[200:203], v[20:23], a[128:131], a[200:203]
    ds_read_b64_tr_b16 a[172:173], v13 offset:26688
    v_mfma_f32_16x16x32_bf16 v[64:67], a[132:135], a[96:99], v[64:67]
    s_waitcnt vmcnt(8)
    v_cmp_ne_u32 vcc, 1, v7
    s_cbranch_vccnz SPIN_go
BACK_go:
    s_lshl2_add_u32 s56, s46, s44
    s_lshl4_add_u32 s56, s56, s45
    s_lshl2_add_u32 s56, s56, 12582912
    buffer_store_dword v8, v5, s[40:43], s56 offen sc1
    ds_read_b64_tr_b16 a[174:175], v13 offset:28480
    v_mfma_f32_16x16x32_bf16 v[68:71], a[132:135], a[100:103], v[68:71]
    ds_read_b64_tr_b16 a[176:177], v13 offset:26720
    v_mfma_f32_16x16x32_bf16 a[204:207], v[20:23], a[132:135], a[204:207]
    ds_read_b64_tr_b16 a[178:179], v13 offset:28512
    v_mfma_f32_16x16x32_bf16 v[72:75], a[136:139], a[96:99], v[72:75]
    ds_read_b64_tr_b16 a[180:181], v13 offset:26752
    v_mfma_f32_16x16x32_bf16 v[76:79], a[136:139], a[100:103], v[76:79]
    ds_read_b64_tr_b16 a[182:183], v13 offset:28544
    v_mfma_f32_16x16x32_bf16 a[208:211], v[20:23], a[136:139], a[208:211]
    ds_read_b64_tr_b16 a[184:185], v13 offset:26784
    v_mfma_f32_16x16x32_bf16 v[80:83], a[140:143], a[96:99], v[80:83]
    ds_read_b64_tr_b16 a[186:187], v13 offset:28576
    v_mfma_f32_16x16x32_bf16 v[84:87], a[140:143], a[100:103], v[84:87]
    ds_read_b64_tr_b16 a[188:189], v13 offset:26816
    v_mfma_f32_16x16x32_bf16 a[212:215], v[20:23], a[140:143], a[212:215]
    ds_read_b64_tr_b16 a[190:191], v13 offset:28608
    v_mfma_f32_16x16x32_bf16 v[88:91], a[144:147], a[96:99], v[88:91]
    ds_read_b128 a[192:195], v17 offset:8192
    v_mfma_f32_16x16x32_bf16 v[92:95], a[144:147], a[100:103], v[92:95]
    ds_read_b128 a[196:199], v17 offset:9216
    v_mfma_f32_16x16x32_bf16 a[216:219], v[20:23], a[144:147], a[216:219]
    v_mfma_f32_16x16x32_bf16 v[96:99], a[148:151], a[96:99], v[96:99]
    v_mfma_f32_16x16x32_bf16 v[100:103], a[148:151], a[100:103], v[100:103]
    v_mfma_f32_16x16x32_bf16 a[220:223], v[20:23], a[148:151], a[220:223]
    v_mfma_f32_16x16x32_bf16 v[104:107], a[152:155], a[96:99], v[104:107]
    v_mfma_f32_16x16x32_bf16 v[108:111], a[152:155], a[100:103], v[108:111]
    v_mfma_f32_16x16x32_bf16 a[224:227], v[20:23], a[152:155], a[224:227]
    v_mfma_f32_16x16x32_bf16 v[112:115], a[96:99], a[156:159], v[112:115]
    v_mfma_f32_16x16x32_bf16 v[116:119], a[100:103], a[156:159], v[116:119]
    v_mfma_f32_16x16x32_bf16 v[120:123], a[96:99], a[160:163], v[120:123]
    v_mfma_f32_16x16x32_bf16 v[124:127], a[100:103], a[160:163], v[124:127]
    v_mfma_f32_16x16x32_bf16 a[228:231], v[20:23], a[104:107], a[228:231]
    v_mfma_f32_16x16x32_bf16 a[236:239], a[104:107], a[104:107], a[236:239]
    v_mfma_f32_16x16x32_bf16 a[232:235], v[20:23], a[108:111], a[232:235]
    s_waitcnt lgkmcnt(0)
    ds_read_b128 a[112:115], v44 offset:22528
    ds_read_b128 a[116:119], v44 offset:24576
    v_mfma_f32_16x16x32_bf16 a[240:243], a[108:111], a[108:111], a[240:243]
    s_lshl_b32 s52, s44, 9
    ds_read_b128 a[120:123], v45 offset:22528
    ds_read_b128 a[124:127], v45 offset:24576
    v_mfma_f32_16x16x32_bf16 v[56:59], a[164:167], a[104:107], v[56:59]
    s_add_u32 s52, s52, 159744
    ds_read_b64_tr_b16 a[128:129], v14 offset:26624
    v_mfma_f32_16x16x32_bf16 v[60:63], a[164:167], a[108:111], v[60:63]
    v_lshlrev_b32 v55, 2, v1
    ds_read_b64_tr_b16 a[130:131], v14 offset:28416
    v_mfma_f32_16x16x32_bf16 v[64:67], a[168:171], a[104:107], v[64:67]
    v_add_u32 v55, s52, v55
    ds_read_b64_tr_b16 a[132:133], v14 offset:26656
    v_mfma_f32_16x16x32_bf16 v[68:71], a[168:171], a[108:111], v[68:71]
    s_add_u32 s67, s65, 4096
    s_cmp_ge_u32 s67, 28672
    s_cselect_b32 s53, 28672, 0
    s_sub_u32 s67, s67, s53
    s_lshl_b32 s67, s67, 4
    s_add_u32 m0, s66, 8192
    s_nop 0
    buffer_load_dwordx4 v49, s[24:27], s67 offen offset:0 lds
    ds_write_b32 v55, a200 offset:0
    ds_read_b64_tr_b16 a[134:135], v14 offset:28448
    v_mfma_f32_16x16x32_bf16 v[72:75], a[172:175], a[104:107], v[72:75]
    ds_write_b32 v55, a204 offset:64
    ds_read_b64_tr_b16 a[136:137], v14 offset:26688
    v_mfma_f32_16x16x32_bf16 v[76:79], a[172:175], a[108:111], v[76:79]
    ds_write_b32 v55, a208 offset:128
    ds_read_b64_tr_b16 a[138:139], v14 offset:28480
    v_mfma_f32_16x16x32_bf16 v[80:83], a[176:179], a[104:107], v[80:83]
    ds_write_b32 v55, a212 offset:192
    ds_read_b64_tr_b16 a[140:141], v14 offset:26720
    v_mfma_f32_16x16x32_bf16 v[84:87], a[176:179], a[108:111], v[84:87]
    buffer_load_dwordx4 v50, s[24:27], s67 offen offset:1024 lds
    ds_write_b32 v55, a216 offset:256
    ds_read_b64_tr_b16 a[142:143], v14 offset:28512
    v_mfma_f32_16x16x32_bf16 v[88:91], a[180:183], a[104:107], v[88:91]
    ds_write_b32 v55, a220 offset:320
    ds_read_b64_tr_b16 a[144:145], v14 offset:26752
    v_mfma_f32_16x16x32_bf16 v[92:95], a[180:183], a[108:111], v[92:95]
    ds_write_b32 v55, a224 offset:384
    ds_read_b64_tr_b16 a[146:147], v14 offset:28544
    v_mfma_f32_16x16x32_bf16 v[96:99], a[184:187], a[104:107], v[96:99]
    ds_read_b64_tr_b16 a[148:149], v14 offset:26784
    v_mfma_f32_16x16x32_bf16 v[100:103], a[184:187], a[108:111], v[100:103]
    buffer_load_dwordx4 v51, s[24:27], s67 offen offset:2048 lds
    ds_read_b64_tr_b16 a[150:151], v14 offset:28576
    v_mfma_f32_16x16x32_bf16 v[104:107], a[188:191], a[104:107], v[104:107]
    ds_read_b64_tr_b16 a[152:153], v14 offset:26816
    v_mfma_f32_16x16x32_bf16 v[108:111], a[188:191], a[108:111], v[108:111]
    ds_read_b64_tr_b16 a[154:155], v14 offset:28608
    v_mfma_f32_16x16x32_bf16 v[112:115], a[104:107], a[192:195], v[112:115]
    ds_read_b128 a[156:159], v18 offset:8192
    v_mfma_f32_16x16x32_bf16 v[116:119], a[108:111], a[192:195], v[116:119]
    buffer_load_dwordx4 v52, s[24:27], s67 offen offset:3072 lds
    ds_read_b128 a[160:163], v18 offset:9216
    v_mfma_f32_16x16x32_bf16 v[120:123], a[104:107], a[196:199], v[120:123]
    v_mfma_f32_16x16x32_bf16 v[124:127], a[108:111], a[196:199], v[124:127]
    s_waitcnt lgkmcnt(14)
    v_mfma_f32_16x16x32_bf16 a[228:231], v[20:23], a[112:115], a[228:231]
    v_mfma_f32_16x16x32_bf16 a[236:239], a[112:115], a[112:115], a[236:239]
    v_mfma_f32_16x16x32_bf16 a[232:235], v[20:23], a[116:119], a[232:235]
    s_waitcnt lgkmcnt(0)
    s_barrier
    ds_read_b64_tr_b16 a[164:165], v15 offset:26624
    v_mfma_f32_16x16x32_bf16 a[240:243], a[116:119], a[116:119], a[240:243]
    v_and_b32 v55, 31, v0
    ds_read_b64_tr_b16 a[166:167], v15 offset:28416
    v_mfma_f32_16x16x32_bf16 v[56:59], a[128:131], a[112:115], v[56:59]
    v_lshlrev_b32 v55, 4, v55
    ds_read_b64_tr_b16 a[168:169], v15 offset:26656
    v_mfma_f32_16x16x32_bf16 v[60:63], a[128:131], a[116:119], v[60:63]
    v_add_u32 v55, 159744, v55
    ds_read_b64_tr_b16 a[170:171], v15 offset:28448
    v_mfma_f32_16x16x32_bf16 v[64:67], a[132:135], a[112:115], v[64:67]
    ds_read_b128 v[192:195], v55 offset:0
    ds_read_b64_tr_b16 a[172:173], v15 offset:26688
    v_mfma_f32_16x16x32_bf16 v[68:71], a[132:135], a[116:119], v[68:71]
    ds_read_b128 v[196:199], v55 offset:512
    ds_read_b64_tr_b16 a[174:175], v15 offset:28480
    v_mfma_f32_16x16x32_bf16 v[72:75], a[136:139], a[112:115], v[72:75]
    ds_read_b128 v[200:203], v55 offset:1024
    ds_read_b64_tr_b16 a[176:177], v15 offset:26720
    v_mfma_f32_16x16x32_bf16 v[76:79], a[136:139], a[116:119], v[76:79]
    ds_read_b128 v[204:207], v55 offset:1536
    ds_read_b64_tr_b16 a[178:179], v15 offset:28512
    v_mfma_f32_16x16x32_bf16 v[80:83], a[140:143], a[112:115], v[80:83]
    v_lshlrev_b32 v208, 16, v46
    ds_read_b64_tr_b16 a[180:181], v15 offset:26752
    v_mfma_f32_16x16x32_bf16 v[84:87], a[140:143], a[116:119], v[84:87]
    v_and_b32 v209, 0xffff0000, v46
    ds_read_b64_tr_b16 a[182:183], v15 offset:28544
    v_mfma_f32_16x16x32_bf16 v[88:91], a[144:147], a[112:115], v[88:91]
    v_lshlrev_b32 v210, 16, v47
    ds_read_b64_tr_b16 a[184:185], v15 offset:26784
    v_mfma_f32_16x16x32_bf16 v[92:95], a[144:147], a[116:119], v[92:95]
    v_and_b32 v211, 0xffff0000, v47
    ds_read_b64_tr_b16 a[186:187], v15 offset:28576
    v_mfma_f32_16x16x32_bf16 v[96:99], a[148:151], a[112:115], v[96:99]
    ds_read_b64_tr_b16 a[188:189], v15 offset:26816
    v_mfma_f32_16x16x32_bf16 v[100:103], a[148:151], a[116:119], v[100:103]
    ds_read_b64_tr_b16 a[190:191], v15 offset:28608
    v_mfma_f32_16x16x32_bf16 v[104:107], a[152:155], a[112:115], v[104:107]
    ds_read_b128 a[192:195], v19 offset:8192
    v_mfma_f32_16x16x32_bf16 v[108:111], a[152:155], a[116:119], v[108:111]
    ds_read_b128 a[196:199], v19 offset:9216
    v_mfma_f32_16x16x32_bf16 v[112:115], a[112:115], a[156:159], v[112:115]
    v_mfma_f32_16x16x32_bf16 v[116:119], a[116:119], a[156:159], v[116:119]
    v_mfma_f32_16x16x32_bf16 v[120:123], a[112:115], a[160:163], v[120:123]
    v_mfma_f32_16x16x32_bf16 v[124:127], a[116:119], a[160:163], v[124:127]
    v_mfma_f32_16x16x32_bf16 a[228:231], v[20:23], a[120:123], a[228:231]
    s_waitcnt lgkmcnt(13)
    v_add_f32 v192, v192, v196
    v_mfma_f32_16x16x32_bf16 a[236:239], a[120:123], a[120:123], a[236:239]
    s_waitcnt lgkmcnt(9)
    v_add_f32 v200, v200, v204
    v_mfma_f32_16x16x32_bf16 a[232:235], v[20:23], a[124:127], a[232:235]
    v_add_f32 v193, v193, v197
    v_mfma_f32_16x16x32_bf16 a[240:243], a[124:127], a[124:127], a[240:243]
    v_add_f32 v201, v201, v205
    v_mfma_f32_16x16x32_bf16 v[56:59], a[164:167], a[120:123], v[56:59]
    v_add_f32 v194, v194, v198
    v_mfma_f32_16x16x32_bf16 v[60:63], a[164:167], a[124:127], v[60:63]
    v_add_f32 v202, v202, v206
    v_mfma_f32_16x16x32_bf16 v[64:67], a[168:171], a[120:123], v[64:67]
    v_add_f32 v195, v195, v199
    v_mfma_f32_16x16x32_bf16 v[68:71], a[168:171], a[124:127], v[68:71]
    s_add_u32 s67, s65, 6144
    s_cmp_ge_u32 s67, 28672
    s_cselect_b32 s53, 28672, 0
    s_sub_u32 s67, s67, s53
    s_lshl_b32 s67, s67, 4
    s_add_u32 m0, s66, 12288
    s_nop 0
    buffer_load_dwordx4 v49, s[24:27], s67 offen offset:0 lds
    v_add_f32 v203, v203, v207
    v_mfma_f32_16x16x32_bf16 v[72:75], a[172:175], a[120:123], v[72:75]
    v_add_f32 v192, v192, v200
    v_mfma_f32_16x16x32_bf16 v[76:79], a[172:175], a[124:127], v[76:79]
    v_add_f32 v193, v193, v201
    s_waitcnt lgkmcnt(8)
    v_mfma_f32_16x16x32_bf16 v[80:83], a[176:179], a[120:123], v[80:83]
    v_add_f32 v194, v194, v202
    v_mfma_f32_16x16x32_bf16 v[84:87], a[176:179], a[124:127], v[84:87]
    buffer_load_dwordx4 v50, s[24:27], s67 offen offset:1024 lds
    v_add_f32 v195, v195, v203
    s_waitcnt lgkmcnt(6)
    v_mfma_f32_16x16x32_bf16 v[88:91], a[180:183], a[120:123], v[88:91]
    v_lshlrev_b32 v54, 4, v0
    v_mfma_f32_16x16x32_bf16 v[92:95], a[180:183], a[124:127], v[92:95]
    v_add_u32 v54, 162304, v54
    s_waitcnt lgkmcnt(4)
    v_mfma_f32_16x16x32_bf16 v[96:99], a[184:187], a[120:123], v[96:99]
    ds_write_b128 v55, v[192:195] offset:2048
    v_mfma_f32_16x16x32_bf16 v[100:103], a[184:187], a[124:127], v[100:103]
    buffer_load_dwordx4 v51, s[24:27], s67 offen offset:2048 lds
    ds_write_b128 v54, v[208:211]
    s_waitcnt lgkmcnt(4)
    v_mfma_f32_16x16x32_bf16 v[104:107], a[188:191], a[120:123], v[104:107]
    v_mfma_f32_16x16x32_bf16 v[108:111], a[188:191], a[124:127], v[108:111]
    s_waitcnt lgkmcnt(3)
    v_mfma_f32_16x16x32_bf16 v[112:115], a[120:123], a[192:195], v[112:115]
    v_mfma_f32_16x16x32_bf16 v[116:119], a[124:127], a[192:195], v[116:119]
    buffer_load_dwordx4 v52, s[24:27], s67 offen offset:3072 lds
    s_waitcnt lgkmcnt(2)
    v_mfma_f32_16x16x32_bf16 v[120:123], a[120:123], a[196:199], v[120:123]
    v_mfma_f32_16x16x32_bf16 v[124:127], a[124:127], a[196:199], v[124:127]
    v_lshrrev_b32 v192, 2, v1
    v_lshl_add_u32 v192, v192, 4, v1
    v_lshlrev_b32 v192, 2, v192
    v_lshlrev_b32 v193, 4, v2
    v_accvgpr_read_b32 v196, a236
    v_accvgpr_read_b32 v197, a237
    v_accvgpr_read_b32 v198, a238
    v_accvgpr_read_b32 v199, a239
    v_cndmask_b32 v196, v196, v197, s[76:77]
    v_cndmask_b32 v196, v196, v198, s[78:79]
    v_cndmask_b32 v196, v196, v199, s[80:81]
    ds_bpermute_b32 v196, v192, v196
    v_accvgpr_read_b32 v197, a228
    v_mul_f32 v197, 0x3b000000, v197
    v_mul_f32 v198, v197, v197
    v_accvgpr_read_b32 v200, a240
    v_accvgpr_read_b32 v201, a241
    v_accvgpr_read_b32 v202, a242
    v_accvgpr_read_b32 v203, a243
    v_cndmask_b32 v200, v200, v201, s[76:77]
    v_cndmask_b32 v200, v200, v202, s[78:79]
    v_cndmask_b32 v200, v200, v203, s[80:81]
    ds_bpermute_b32 v200, v192, v200
    v_accvgpr_read_b32 v201, a232
    v_mul_f32 v201, 0x3b000000, v201
    v_mul_f32 v202, v201, v201
    s_cmp_eq_u32 s46, 15
    s_cselect_b32 s52, 15, 16
    v_cmp_eq_u32 vcc, s52, v1
    v_mov_b32 v194, 0x36000000
    v_mov_b32 v195, 0x35800000
    v_cndmask_b32 v194, v194, v195, vcc
    v_mul_f32 v194, v194, v48
    s_waitcnt lgkmcnt(1)
    v_mul_f32 v196, 0x3b000000, v196
    v_sub_f32 v196, v196, v198
    v_max_f32 v196, 0, v196
    v_add_f32 v198, 0x3727c5ac, v196
    v_rsq_f32 v198, v198
    s_nop 0
    ds_bpermute_b32 v204, v193, v198 offset:0
    ds_bpermute_b32 v205, v193, v198 offset:4
    ds_bpermute_b32 v206, v193, v198 offset:8
    ds_bpermute_b32 v207, v193, v198 offset:12
    s_waitcnt lgkmcnt(4)
    v_mul_f32 v200, 0x3b000000, v200
    v_sub_f32 v200, v200, v202
    v_max_f32 v200, 0, v200
    v_add_f32 v202, 0x3727c5ac, v200
    v_rsq_f32 v202, v202
    s_nop 0
    ds_bpermute_b32 v208, v193, v202 offset:0
    ds_bpermute_b32 v209, v193, v202 offset:4
    ds_bpermute_b32 v210, v193, v202 offset:8
    ds_bpermute_b32 v211, v193, v202 offset:12
    v_mul_f32 v196, v196, v198
    v_fmaak_f32 v196, v196, v198, 0x3727c5ac
    v_rsq_f32 v196, v196
    s_nop 0
    v_mul_f32 v12, v196, v198
    v_mul_f32 v14, v12, -v197
    v_mul_f32 v200, v200, v202
    v_fmaak_f32 v200, v200, v202, 0x3727c5ac
    v_rsq_f32 v200, v200
    s_nop 0
    v_mul_f32 v13, v200, v202
    v_mul_f32 v15, v13, -v201
    s_waitcnt lgkmcnt(6)
    v_pk_mul_f32 v[204:205], v[204:205], v[194:195] op_sel_hi:[1,0]
    s_waitcnt lgkmcnt(4)
    v_pk_mul_f32 v[206:207], v[206:207], v[194:195] op_sel_hi:[1,0]
    s_waitcnt lgkmcnt(2)
    v_pk_mul_f32 v[208:209], v[208:209], v[194:195] op_sel_hi:[1,0]
    s_waitcnt lgkmcnt(0)
    v_pk_mul_f32 v[210:211], v[210:211], v[194:195] op_sel_hi:[1,0]
    v_pk_mul_f32 v[112:113], v[112:113], v[204:205]
    v_pk_mul_f32 v[114:115], v[114:115], v[206:207]
    v_pk_mul_f32 v[116:117], v[116:117], v[208:209]
    v_pk_mul_f32 v[118:119], v[118:119], v[210:211]
    v_pk_mul_f32 v[120:121], v[120:121], v[204:205]
    v_pk_mul_f32 v[122:123], v[122:123], v[206:207]
    v_pk_mul_f32 v[124:125], v[124:125], v[208:209]
    v_pk_mul_f32 v[126:127], v[126:127], v[210:211]
    v_cvt_pk_bf16_f32 v192, v112, v113
    v_cvt_pk_bf16_f32 v196, v120, v121
    v_cvt_pk_bf16_f32 v200, -v112, -v113
    v_cvt_pk_bf16_f32 v193, v114, v115
    v_cvt_pk_bf16_f32 v197, v122, v123
    v_cvt_pk_bf16_f32 v201, -v114, -v115
    v_cvt_pk_bf16_f32 v194, v116, v117
    v_cvt_pk_bf16_f32 v198, v124, v125
    v_cvt_pk_bf16_f32 v202, -v116, -v117
    v_cvt_pk_bf16_f32 v195, v118, v119
    v_cvt_pk_bf16_f32 v199, v126, v127
    v_cvt_pk_bf16_f32 v203, -v118, -v119
    v_mfma_f32_16x16x32_bf16 v[112:115], v[24:27], v[192:195], 0
    v_mfma_f32_16x16x32_bf16 v[116:119], v[24:27], v[196:199], 0
    v_mfma_f32_16x16x32_bf16 v[120:123], v[32:35], v[192:195], 0
    v_mfma_f32_16x16x32_bf16 v[124:127], v[32:35], v[196:199], 0
    v_mfma_f32_16x16x32_bf16 v[112:115], v[28:31], v[196:199], v[112:115]
    v_mfma_f32_16x16x32_bf16 v[116:119], v[28:31], v[200:203], v[116:119]
    v_mfma_f32_16x16x32_bf16 v[120:123], v[36:39], v[196:199], v[120:123]
    v_mfma_f32_16x16x32_bf16 v[124:127], v[36:39], v[200:203], v[124:127]
    s_lshl2_add_u32 s52, s44, 151552
    v_lshlrev_b32 v204, 10, v2
    v_lshl_add_u32 v204, v1, 4, v204
    v_add_u32 v204, s52, v204
    s_lshl_b32 s52, s44, 11
    s_add_u32 s52, s52, 151552
    v_lshlrev_b32 v205, 4, v0
    v_add_u32 v205, s52, v205
    v_cvt_pk_bf16_f32 v192, v112, v116
    ds_write_b32 v204, v192 offset:0
    v_cvt_pk_bf16_f32 v193, v113, v117
    ds_write_b32 v204, v193 offset:256
    v_cvt_pk_bf16_f32 v194, v114, v118
    ds_write_b32 v204, v194 offset:512
    v_cvt_pk_bf16_f32 v195, v115, v119
    ds_write_b32 v204, v195 offset:768
    v_cvt_pk_bf16_f32 v196, v120, v124
    ds_write_b32 v204, v196 offset:4096
    v_cvt_pk_bf16_f32 v197, v121, v125
    ds_write_b32 v204, v197 offset:4352
    v_cvt_pk_bf16_f32 v198, v122, v126
    ds_write_b32 v204, v198 offset:4608
    v_cvt_pk_bf16_f32 v199, v123, v127
    ds_write_b32 v204, v199 offset:4864
    s_waitcnt lgkmcnt(0)
    s_barrier
    ds_read_b128 v[192:195], v205
    ds_read_b128 v[196:199], v205 offset:1024
    s_waitcnt lgkmcnt(1)
    buffer_store_dwordx4 v[192:195], v221, s[40:43], 0 offen sc1
    s_waitcnt lgkmcnt(0)
    buffer_store_dwordx4 v[196:199], v222, s[40:43], 0 offen sc1
    s_mov_b32 s74, 0xbdd2d3e8
    v_mov_b32 v16, 0xc0135761
    v_lshlrev_b32 v17, 4, v2
    v_add_u32 v17, 161792, v17
    v_lshlrev_b32 v18, 4, v0
    s_lshl2_add_u32 s52, s45, s44
    s_mul_i32 s52, s52, 112
    s_mul_i32 s53, s46, 7
    s_add_u32 s52, s52, s53
    s_lshl_b32 s75, s52, 10
    s_add_u32 s57, s75, 4096
    ds_read_b128 v[112:115], v17
    ds_read_b128 v[120:123], v17 offset:512
    ds_read_b128 v[116:119], v17 offset:64
    ds_read_b128 v[124:127], v17 offset:576
    s_waitcnt lgkmcnt(2)
    v_pk_fma_f32 v[232:233], v[112:113], v[14:15], v[120:121] op_sel_hi:[1,0,1]
    s_lshr_b32 s60, s62, 3
    s_lshl2_add_u32 s60, s48, s60
    s_lshl_b32 s60, s60, 6
    s_add_u32 s60, s60, 12582912
    v_lshlrev_b32 v6, 2, v1
    buffer_load_dword v7, v6, s[40:43], s60 offen sc1
    v_pk_fma_f32 v[234:235], v[114:115], v[14:15], v[122:123] op_sel_hi:[1,0,1]
    s_add_u32 s67, s65, 8192
    s_cmp_ge_u32 s67, 28672
    s_cselect_b32 s53, 28672, 0
    s_sub_u32 s67, s67, s53
    s_lshl_b32 s67, s67, 4
    s_add_u32 m0, s66, 16384
    s_nop 0
    buffer_load_dwordx4 v49, s[24:27], s67 offen offset:0 lds
    v_pk_fma_f32 v[224:225], v[112:113], v[14:15], v[120:121] op_sel:[0,1,0] op_sel_hi:[1,1,1]
    buffer_load_dwordx4 v50, s[24:27], s67 offen offset:1024 lds
    v_pk_fma_f32 v[226:227], v[114:115], v[14:15], v[122:123] op_sel:[0,1,0] op_sel_hi:[1,1,1]
    buffer_load_dwordx4 v51, s[24:27], s67 offen offset:2048 lds
    v_pk_fma_f32 v[232:233], v[56:57], v[12:13], v[232:233] op_sel_hi:[1,0,1]
    buffer_load_dwordx4 v52, s[24:27], s67 offen offset:3072 lds
    v_pk_fma_f32 v[234:235], v[58:59], v[12:13], v[234:235] op_sel_hi:[1,0,1]
    s_add_u32 s67, s65, 10240
    s_cmp_ge_u32 s67, 28672
    s_cselect_b32 s53, 28672, 0
    s_sub_u32 s67, s67, s53
    s_lshl_b32 s67, s67, 4
    s_add_u32 m0, s66, 20480
    s_nop 0
    buffer_load_dwordx4 v49, s[24:27], s67 offen offset:0 lds
    v_pk_fma_f32 v[224:225], v[60:61], v[12:13], v[224:225] op_sel:[0,1,0] op_sel_hi:[1,1,1]
    buffer_load_dwordx4 v50, s[24:27], s67 offen offset:1024 lds
    v_pk_fma_f32 v[226:227], v[62:63], v[12:13], v[226:227] op_sel:[0,1,0] op_sel_hi:[1,1,1]
    buffer_load_dwordx4 v51, s[24:27], s67 offen offset:2048 lds
    v_pk_mul_f32 v[236:237], v[232:233], v[232:233]
    buffer_load_dwordx4 v52, s[24:27], s67 offen offset:3072 lds
    v_pk_mul_f32 v[238:239], v[234:235], v[234:235]
    s_waitcnt vmcnt(24)
    ds_read_b64_tr_b16 a[0:1], v3 offset:0
    v_pk_mul_f32 v[228:229], v[224:225], v[224:225]
    ds_read_b64_tr_b16 a[2:3], v3 offset:512
    v_pk_mul_f32 v[230:231], v[226:227], v[226:227]
    ds_read_b64_tr_b16 a[4:5], v4 offset:0
    v_pk_fma_f32 v[236:237], v[236:237], s[74:75], v[16:17] op_sel_hi:[1,0,0]
    ds_read_b64_tr_b16 a[6:7], v4 offset:512
    v_pk_fma_f32 v[238:239], v[238:239], s[74:75], v[16:17] op_sel_hi:[1,0,0]
    ds_read_b64_tr_b16 a[8:9], v3 offset:2048
    v_pk_fma_f32 v[228:229], v[228:229], s[74:75], v[16:17] op_sel_hi:[1,0,0]
    ds_read_b64_tr_b16 a[10:11], v3 offset:2560
    v_pk_fma_f32 v[230:231], v[230:231], s[74:75], v[16:17] op_sel_hi:[1,0,0]
    ds_read_b64_tr_b16 a[12:13], v4 offset:2048
    v_pk_mul_f32 v[236:237], v[236:237], v[232:233]
    ds_read_b64_tr_b16 a[14:15], v4 offset:2560
    v_pk_mul_f32 v[238:239], v[238:239], v[234:235]
    s_waitcnt vmcnt(20)
    ds_read_b64_tr_b16 a[16:17], v3 offset:4096
    v_pk_mul_f32 v[228:229], v[228:229], v[224:225]
    ds_read_b64_tr_b16 a[18:19], v3 offset:4608
    v_pk_mul_f32 v[230:231], v[230:231], v[226:227]
    ds_read_b64_tr_b16 a[20:21], v4 offset:4096
    v_exp_f32 v236, v236
    ds_read_b64_tr_b16 a[22:23], v4 offset:4608
    v_exp_f32 v237, v237
    ds_read_b64_tr_b16 a[24:25], v3 offset:6144
    v_exp_f32 v238, v238
    ds_read_b64_tr_b16 a[26:27], v3 offset:6656
    v_exp_f32 v239, v239
    ds_read_b64_tr_b16 a[28:29], v4 offset:6144
    v_exp_f32 v228, v228
    ds_read_b64_tr_b16 a[30:31], v4 offset:6656
    v_exp_f32 v229, v229
    s_lshr_b32 s52, s44, 1
    s_lshl1_add_u32 s52, s49, s52
    s_lshl_b32 s52, s52, 10
    s_and_b32 s72, s44, 1
    s_lshl1_add_u32 s72, s50, s72
    s_lshl_b32 s72, s72, 6
    s_add_u32 s71, s52, s72
    v_and_b32 v19, 3, v0
    v_bfe_u32 v9, v0, 3, 2
    v_lshl_add_u32 v19, v9, 2, v19
    v_and_b32 v9, 4, v0
    v_lshl_add_u32 v19, v9, 2, v19
    v_and_b32 v9, 32, v0
    v_lshl_add_u32 v19, v9, 5, v19
    v_lshlrev_b32 v19, 1, v19
    buffer_load_ushort v19, v19, s[28:31], s72 offen
    v_exp_f32 v230, v230
    v_exp_f32 v231, v231
    v_pk_add_f32 v[236:237], v[236:237], 1.0 op_sel_hi:[1,0]
    v_pk_add_f32 v[238:239], v[238:239], 1.0 op_sel_hi:[1,0]
    v_pk_add_f32 v[228:229], v[228:229], 1.0 op_sel_hi:[1,0]
    v_pk_add_f32 v[230:231], v[230:231], 1.0 op_sel_hi:[1,0]
    v_rcp_f32 v236, v236
    v_rcp_f32 v237, v237
    v_rcp_f32 v238, v238
    v_rcp_f32 v239, v239
    v_rcp_f32 v228, v228
    v_rcp_f32 v229, v229
    v_rcp_f32 v230, v230
    v_rcp_f32 v231, v231
    v_pk_mul_f32 v[232:233], v[232:233], v[236:237]
    v_pk_mul_f32 v[234:235], v[234:235], v[238:239]
    v_pk_mul_f32 v[224:225], v[224:225], v[228:229]
    v_pk_mul_f32 v[226:227], v[226:227], v[230:231]
    v_cvt_pk_bf16_f32 v56, v232, v233
    v_cvt_pk_bf16_f32 v57, v234, v235
    v_cvt_pk_bf16_f32 v58, v224, v225
    v_cvt_pk_bf16_f32 v59, v226, v227
    s_nop 0
    v_permlane16_swap_b32 v56, v58
    v_permlane16_swap_b32 v57, v59
    buffer_store_dwordx4 v[56:59], v18, s[40:43], s75 offen offset:0 sc1
    ds_read_b128 v[112:115], v17 offset:128
    ds_read_b128 v[120:123], v17 offset:640
    s_waitcnt lgkmcnt(14)
    v_pk_fma_f32 v[232:233], v[116:117], v[14:15], v[124:125] op_sel_hi:[1,0,1]
    v_pk_fma_f32 v[234:235], v[118:119], v[14:15], v[126:127] op_sel_hi:[1,0,1]
    v_pk_fma_f32 v[224:225], v[116:117], v[14:15], v[124:125] op_sel:[0,1,0] op_sel_hi:[1,1,1]
    s_add_u32 s67, s65, 12288
    s_cmp_ge_u32 s67, 28672
    s_cselect_b32 s53, 28672, 0
    s_sub_u32 s67, s67, s53
    s_lshl_b32 s67, s67, 4
    s_add_u32 m0, s66, 24576
    s_nop 0
    buffer_load_dwordx4 v49, s[24:27], s67 offen offset:0 lds
    v_pk_fma_f32 v[226:227], v[118:119], v[14:15], v[126:127] op_sel:[0,1,0] op_sel_hi:[1,1,1]
    v_pk_fma_f32 v[232:233], v[64:65], v[12:13], v[232:233] op_sel_hi:[1,0,1]
    v_pk_fma_f32 v[234:235], v[66:67], v[12:13], v[234:235] op_sel_hi:[1,0,1]
    buffer_load_dwordx4 v50, s[24:27], s67 offen offset:1024 lds
    v_pk_fma_f32 v[224:225], v[68:69], v[12:13], v[224:225] op_sel:[0,1,0] op_sel_hi:[1,1,1]
    v_pk_fma_f32 v[226:227], v[70:71], v[12:13], v[226:227] op_sel:[0,1,0] op_sel_hi:[1,1,1]
    v_pk_mul_f32 v[236:237], v[232:233], v[232:233]
    buffer_load_dwordx4 v51, s[24:27], s67 offen offset:2048 lds
    v_pk_mul_f32 v[238:239], v[234:235], v[234:235]
    v_pk_mul_f32 v[228:229], v[224:225], v[224:225]
    v_pk_mul_f32 v[230:231], v[226:227], v[226:227]
    buffer_load_dwordx4 v52, s[24:27], s67 offen offset:3072 lds
    v_pk_fma_f32 v[236:237], v[236:237], s[74:75], v[16:17] op_sel_hi:[1,0,0]
    v_pk_fma_f32 v[238:239], v[238:239], s[74:75], v[16:17] op_sel_hi:[1,0,0]
    v_pk_fma_f32 v[228:229], v[228:229], s[74:75], v[16:17] op_sel_hi:[1,0,0]
    s_add_u32 s67, s65, 14336
    s_cmp_ge_u32 s67, 28672
    s_cselect_b32 s53, 28672, 0
    s_sub_u32 s67, s67, s53
    s_lshl_b32 s67, s67, 4
    s_add_u32 m0, s66, 28672
    s_nop 0
    buffer_load_dwordx4 v49, s[24:27], s67 offen offset:0 lds
    v_pk_fma_f32 v[230:231], v[230:231], s[74:75], v[16:17] op_sel_hi:[1,0,0]
    v_pk_mul_f32 v[236:237], v[236:237], v[232:233]
    v_pk_mul_f32 v[238:239], v[238:239], v[234:235]
    buffer_load_dwordx4 v50, s[24:27], s67 offen offset:1024 lds
    v_pk_mul_f32 v[228:229], v[228:229], v[224:225]
    v_pk_mul_f32 v[230:231], v[230:231], v[226:227]
    v_exp_f32 v236, v236
    buffer_load_dwordx4 v51, s[24:27], s67 offen offset:2048 lds
    v_exp_f32 v237, v237
    v_exp_f32 v238, v238
    v_exp_f32 v239, v239
    buffer_load_dwordx4 v52, s[24:27], s67 offen offset:3072 lds
    v_exp_f32 v228, v228
    v_exp_f32 v229, v229
    v_exp_f32 v230, v230
    s_waitcnt vmcnt(25)
    ds_read_b64_tr_b16 a[32:33], v3 offset:8192
    v_exp_f32 v231, v231
    v_pk_add_f32 v[236:237], v[236:237], 1.0 op_sel_hi:[1,0]
    v_pk_add_f32 v[238:239], v[238:239], 1.0 op_sel_hi:[1,0]
    ds_read_b64_tr_b16 a[34:35], v3 offset:8704
    v_pk_add_f32 v[228:229], v[228:229], 1.0 op_sel_hi:[1,0]
    v_pk_add_f32 v[230:231], v[230:231], 1.0 op_sel_hi:[1,0]
    v_rcp_f32 v236, v236
    ds_read_b64_tr_b16 a[36:37], v4 offset:8192
    v_rcp_f32 v237, v237
    v_rcp_f32 v238, v238
    v_rcp_f32 v239, v239
    ds_read_b64_tr_b16 a[38:39], v4 offset:8704
    v_rcp_f32 v228, v228
    v_rcp_f32 v229, v229
    v_rcp_f32 v230, v230
    ds_read_b64_tr_b16 a[40:41], v3 offset:10240
    v_rcp_f32 v231, v231
    v_pk_mul_f32 v[232:233], v[232:233], v[236:237]
    v_pk_mul_f32 v[234:235], v[234:235], v[238:239]
    ds_read_b64_tr_b16 a[42:43], v3 offset:10752
    v_pk_mul_f32 v[224:225], v[224:225], v[228:229]
    v_pk_mul_f32 v[226:227], v[226:227], v[230:231]
    v_cvt_pk_bf16_f32 v64, v232, v233
    ds_read_b64_tr_b16 a[44:45], v4 offset:10240
    v_cvt_pk_bf16_f32 v65, v234, v235
    v_cvt_pk_bf16_f32 v66, v224, v225
    v_cvt_pk_bf16_f32 v67, v226, v227
    ds_read_b64_tr_b16 a[46:47], v4 offset:10752
    v_permlane16_swap_b32 v64, v66
    v_permlane16_swap_b32 v65, v67
    buffer_store_dwordx4 v[64:67], v18, s[40:43], s75 offen offset:1024 sc1
    ds_read_b128 v[116:119], v17 offset:192
    ds_read_b128 v[124:127], v17 offset:704
    s_waitcnt lgkmcnt(10)
    v_pk_fma_f32 v[232:233], v[112:113], v[14:15], v[120:121] op_sel_hi:[1,0,1]
    v_pk_fma_f32 v[234:235], v[114:115], v[14:15], v[122:123] op_sel_hi:[1,0,1]
    v_pk_fma_f32 v[224:225], v[112:113], v[14:15], v[120:121] op_sel:[0,1,0] op_sel_hi:[1,1,1]
    v_pk_fma_f32 v[226:227], v[114:115], v[14:15], v[122:123] op_sel:[0,1,0] op_sel_hi:[1,1,1]
    s_waitcnt vmcnt(22)
    ds_read_b64_tr_b16 a[48:49], v3 offset:12288
    v_pk_fma_f32 v[232:233], v[72:73], v[12:13], v[232:233] op_sel_hi:[1,0,1]
    v_pk_fma_f32 v[234:235], v[74:75], v[12:13], v[234:235] op_sel_hi:[1,0,1]
    v_pk_fma_f32 v[224:225], v[76:77], v[12:13], v[224:225] op_sel:[0,1,0] op_sel_hi:[1,1,1]
    v_pk_fma_f32 v[226:227], v[78:79], v[12:13], v[226:227] op_sel:[0,1,0] op_sel_hi:[1,1,1]
    ds_read_b64_tr_b16 a[50:51], v3 offset:12800
    v_pk_mul_f32 v[236:237], v[232:233], v[232:233]
    v_pk_mul_f32 v[238:239], v[234:235], v[234:235]
    v_pk_mul_f32 v[228:229], v[224:225], v[224:225]
    v_pk_mul_f32 v[230:231], v[226:227], v[226:227]
    ds_read_b64_tr_b16 a[52:53], v4 offset:12288
    v_pk_fma_f32 v[236:237], v[236:237], s[74:75], v[16:17] op_sel_hi:[1,0,0]
    v_pk_fma_f32 v[238:239], v[238:239], s[74:75], v[16:17] op_sel_hi:[1,0,0]
    v_pk_fma_f32 v[228:229], v[228:229], s[74:75], v[16:17] op_sel_hi:[1,0,0]
    v_pk_fma_f32 v[230:231], v[230:231], s[74:75], v[16:17] op_sel_hi:[1,0,0]
    ds_read_b64_tr_b16 a[54:55], v4 offset:12800
    v_pk_mul_f32 v[236:237], v[236:237], v[232:233]
    v_pk_mul_f32 v[238:239], v[238:239], v[234:235]
    v_pk_mul_f32 v[228:229], v[228:229], v[224:225]
    v_pk_mul_f32 v[230:231], v[230:231], v[226:227]
    ds_read_b64_tr_b16 a[56:57], v3 offset:14336
    v_exp_f32 v236, v236
    v_exp_f32 v237, v237
    v_exp_f32 v238, v238
    v_exp_f32 v239, v239
    ds_read_b64_tr_b16 a[58:59], v3 offset:14848
    v_exp_f32 v228, v228
    v_exp_f32 v229, v229
    v_exp_f32 v230, v230
    v_exp_f32 v231, v231
    ds_read_b64_tr_b16 a[60:61], v4 offset:14336
    v_pk_add_f32 v[236:237], v[236:237], 1.0 op_sel_hi:[1,0]
    v_pk_add_f32 v[238:239], v[238:239], 1.0 op_sel_hi:[1,0]
    v_pk_add_f32 v[228:229], v[228:229], 1.0 op_sel_hi:[1,0]
    v_pk_add_f32 v[230:231], v[230:231], 1.0 op_sel_hi:[1,0]
    ds_read_b64_tr_b16 a[62:63], v4 offset:14848
    v_rcp_f32 v236, v236
    v_rcp_f32 v237, v237
    v_rcp_f32 v238, v238
    v_rcp_f32 v239, v239
    s_add_u32 s64, s63, 0
    buffer_load_short_d16_hi v240, v220, s[8:11], s64 offen offset:2
    buffer_load_short_d16_hi v248, v220, s[12:15], s64 offen offset:2
    v_rcp_f32 v228, v228
    v_rcp_f32 v229, v229
    v_rcp_f32 v230, v230
    v_rcp_f32 v231, v231
    s_add_u32 s64, s63, 16448
    buffer_load_short_d16_hi v241, v220, s[8:11], s64 offen offset:2
    buffer_load_short_d16_hi v249, v220, s[12:15], s64 offen offset:2
    v_pk_mul_f32 v[232:233], v[232:233], v[236:237]
    v_pk_mul_f32 v[234:235], v[234:235], v[238:239]
    v_pk_mul_f32 v[224:225], v[224:225], v[228:229]
    v_pk_mul_f32 v[226:227], v[226:227], v[230:231]
    v_cvt_pk_bf16_f32 v72, v232, v233
    v_cvt_pk_bf16_f32 v73, v234, v235
    v_cvt_pk_bf16_f32 v74, v224, v225
    v_cvt_pk_bf16_f32 v75, v226, v227
    s_nop 0
    v_permlane16_swap_b32 v72, v74
    v_permlane16_swap_b32 v73, v75
    buffer_store_dwordx4 v[72:75], v18, s[40:43], s75 offen offset:2048 sc1
    ds_read_b128 v[112:115], v17 offset:256
    ds_read_b128 v[120:123], v17 offset:768
    s_waitcnt lgkmcnt(10)
    v_pk_fma_f32 v[232:233], v[116:117], v[14:15], v[124:125] op_sel_hi:[1,0,1]
    v_pk_fma_f32 v[234:235], v[118:119], v[14:15], v[126:127] op_sel_hi:[1,0,1]
    v_pk_fma_f32 v[224:225], v[116:117], v[14:15], v[124:125] op_sel:[0,1,0] op_sel_hi:[1,1,1]
    v_pk_fma_f32 v[226:227], v[118:119], v[14:15], v[126:127] op_sel:[0,1,0] op_sel_hi:[1,1,1]
    v_pk_fma_f32 v[232:233], v[80:81], v[12:13], v[232:233] op_sel_hi:[1,0,1]
    v_pk_fma_f32 v[234:235], v[82:83], v[12:13], v[234:235] op_sel_hi:[1,0,1]
    v_pk_fma_f32 v[224:225], v[84:85], v[12:13], v[224:225] op_sel:[0,1,0] op_sel_hi:[1,1,1]
    v_pk_fma_f32 v[226:227], v[86:87], v[12:13], v[226:227] op_sel:[0,1,0] op_sel_hi:[1,1,1]
    v_pk_mul_f32 v[236:237], v[232:233], v[232:233]
    v_pk_mul_f32 v[238:239], v[234:235], v[234:235]
    v_pk_mul_f32 v[228:229], v[224:225], v[224:225]
    v_pk_mul_f32 v[230:231], v[226:227], v[226:227]
    v_pk_fma_f32 v[236:237], v[236:237], s[74:75], v[16:17] op_sel_hi:[1,0,0]
    v_pk_fma_f32 v[238:239], v[238:239], s[74:75], v[16:17] op_sel_hi:[1,0,0]
    v_pk_fma_f32 v[228:229], v[228:229], s[74:75], v[16:17] op_sel_hi:[1,0,0]
    v_pk_fma_f32 v[230:231], v[230:231], s[74:75], v[16:17] op_sel_hi:[1,0,0]
    v_pk_mul_f32 v[236:237], v[236:237], v[232:233]
    v_pk_mul_f32 v[238:239], v[238:239], v[234:235]
    v_pk_mul_f32 v[228:229], v[228:229], v[224:225]
    v_pk_mul_f32 v[230:231], v[230:231], v[226:227]
    v_exp_f32 v236, v236
    v_exp_f32 v237, v237
    v_exp_f32 v238, v238
    v_exp_f32 v239, v239
    s_add_u32 s64, s63, 32896
    buffer_load_short_d16_hi v242, v220, s[8:11], s64 offen offset:2
    buffer_load_short_d16_hi v250, v220, s[12:15], s64 offen offset:2
    v_exp_f32 v228, v228
    v_exp_f32 v229, v229
    v_exp_f32 v230, v230
    v_exp_f32 v231, v231
    v_pk_add_f32 v[236:237], v[236:237], 1.0 op_sel_hi:[1,0]
    v_pk_add_f32 v[238:239], v[238:239], 1.0 op_sel_hi:[1,0]
    v_pk_add_f32 v[228:229], v[228:229], 1.0 op_sel_hi:[1,0]
    v_pk_add_f32 v[230:231], v[230:231], 1.0 op_sel_hi:[1,0]
    v_rcp_f32 v236, v236
    v_rcp_f32 v237, v237
    v_rcp_f32 v238, v238
    v_rcp_f32 v239, v239
    v_rcp_f32 v228, v228
    v_rcp_f32 v229, v229
    v_rcp_f32 v230, v230
    v_rcp_f32 v231, v231
    v_pk_mul_f32 v[232:233], v[232:233], v[236:237]
    v_pk_mul_f32 v[234:235], v[234:235], v[238:239]
    v_pk_mul_f32 v[224:225], v[224:225], v[228:229]
    v_pk_mul_f32 v[226:227], v[226:227], v[230:231]
    v_cvt_pk_bf16_f32 v80, v232, v233
    v_cvt_pk_bf16_f32 v81, v234, v235
    v_cvt_pk_bf16_f32 v82, v224, v225
    v_cvt_pk_bf16_f32 v83, v226, v227
    s_add_u32 s64, s63, 49344
    buffer_load_short_d16_hi v243, v220, s[8:11], s64 offen offset:2
    buffer_load_short_d16_hi v251, v220, s[12:15], s64 offen offset:2
    v_permlane16_swap_b32 v80, v82
    v_permlane16_swap_b32 v81, v83
    buffer_store_dwordx4 v[80:83], v18, s[40:43], s75 offen offset:3072 sc1
    ds_read_b128 v[116:119], v17 offset:320
    ds_read_b128 v[124:127], v17 offset:832
    s_waitcnt lgkmcnt(2)
    v_pk_fma_f32 v[232:233], v[112:113], v[14:15], v[120:121] op_sel_hi:[1,0,1]
    v_pk_fma_f32 v[234:235], v[114:115], v[14:15], v[122:123] op_sel_hi:[1,0,1]
    v_pk_fma_f32 v[224:225], v[112:113], v[14:15], v[120:121] op_sel:[0,1,0] op_sel_hi:[1,1,1]
    v_pk_fma_f32 v[226:227], v[114:115], v[14:15], v[122:123] op_sel:[0,1,0] op_sel_hi:[1,1,1]
    v_pk_fma_f32 v[232:233], v[88:89], v[12:13], v[232:233] op_sel_hi:[1,0,1]
    v_pk_fma_f32 v[234:235], v[90:91], v[12:13], v[234:235] op_sel_hi:[1,0,1]
    v_pk_fma_f32 v[224:225], v[92:93], v[12:13], v[224:225] op_sel:[0,1,0] op_sel_hi:[1,1,1]
    v_pk_fma_f32 v[226:227], v[94:95], v[12:13], v[226:227] op_sel:[0,1,0] op_sel_hi:[1,1,1]
    v_pk_mul_f32 v[236:237], v[232:233], v[232:233]
    v_pk_mul_f32 v[238:239], v[234:235], v[234:235]
    v_pk_mul_f32 v[228:229], v[224:225], v[224:225]
    v_pk_mul_f32 v[230:231], v[226:227], v[226:227]
    v_pk_fma_f32 v[236:237], v[236:237], s[74:75], v[16:17] op_sel_hi:[1,0,0]
    v_pk_fma_f32 v[238:239], v[238:239], s[74:75], v[16:17] op_sel_hi:[1,0,0]
    v_pk_fma_f32 v[228:229], v[228:229], s[74:75], v[16:17] op_sel_hi:[1,0,0]
    v_pk_fma_f32 v[230:231], v[230:231], s[74:75], v[16:17] op_sel_hi:[1,0,0]
    v_pk_mul_f32 v[236:237], v[236:237], v[232:233]
    v_pk_mul_f32 v[238:239], v[238:239], v[234:235]
    v_pk_mul_f32 v[228:229], v[228:229], v[224:225]
    v_pk_mul_f32 v[230:231], v[230:231], v[226:227]
    v_exp_f32 v236, v236
    v_exp_f32 v237, v237
    v_exp_f32 v238, v238
    v_exp_f32 v239, v239
    s_add_u32 s64, s63, 263168
    buffer_load_short_d16_hi v244, v220, s[8:11], s64 offen offset:2
    buffer_load_short_d16_hi v252, v220, s[12:15], s64 offen offset:2
    v_exp_f32 v228, v228
    v_exp_f32 v229, v229
    v_exp_f32 v230, v230
    v_exp_f32 v231, v231
    v_pk_add_f32 v[236:237], v[236:237], 1.0 op_sel_hi:[1,0]
    v_pk_add_f32 v[238:239], v[238:239], 1.0 op_sel_hi:[1,0]
    v_pk_add_f32 v[228:229], v[228:229], 1.0 op_sel_hi:[1,0]
    v_pk_add_f32 v[230:231], v[230:231], 1.0 op_sel_hi:[1,0]
    v_rcp_f32 v236, v236
    v_rcp_f32 v237, v237
    v_rcp_f32 v238, v238
    v_rcp_f32 v239, v239
    v_rcp_f32 v228, v228
    v_rcp_f32 v229, v229
    v_rcp_f32 v230, v230
    v_rcp_f32 v231, v231
    v_pk_mul_f32 v[232:233], v[232:233], v[236:237]
    v_pk_mul_f32 v[234:235], v[234:235], v[238:239]
    v_pk_mul_f32 v[224:225], v[224:225], v[228:229]
    v_pk_mul_f32 v[226:227], v[226:227], v[230:231]
    v_cvt_pk_bf16_f32 v88, v232, v233
    v_cvt_pk_bf16_f32 v89, v234, v235
    v_cvt_pk_bf16_f32 v90, v224, v225
    v_cvt_pk_bf16_f32 v91, v226, v227
    s_add_u32 s64, s63, 279616
    buffer_load_short_d16_hi v245, v220, s[8:11], s64 offen offset:2
    buffer_load_short_d16_hi v253, v220, s[12:15], s64 offen offset:2
    v_permlane16_swap_b32 v88, v90
    v_permlane16_swap_b32 v89, v91
    buffer_store_dwordx4 v[88:91], v18, s[40:43], s57 offen offset:0 sc1
    ds_read_b128 v[112:115], v17 offset:384
    ds_read_b128 v[120:123], v17 offset:896
    s_waitcnt lgkmcnt(2)
    v_pk_fma_f32 v[232:233], v[116:117], v[14:15], v[124:125] op_sel_hi:[1,0,1]
    v_pk_fma_f32 v[234:235], v[118:119], v[14:15], v[126:127] op_sel_hi:[1,0,1]
    v_pk_fma_f32 v[224:225], v[116:117], v[14:15], v[124:125] op_sel:[0,1,0] op_sel_hi:[1,1,1]
    v_pk_fma_f32 v[226:227], v[118:119], v[14:15], v[126:127] op_sel:[0,1,0] op_sel_hi:[1,1,1]
    s_waitcnt vmcnt(30)
    ds_read_b64_tr_b16 a[64:65], v3 offset:16384
    v_pk_fma_f32 v[232:233], v[96:97], v[12:13], v[232:233] op_sel_hi:[1,0,1]
    v_pk_fma_f32 v[234:235], v[98:99], v[12:13], v[234:235] op_sel_hi:[1,0,1]
    v_pk_fma_f32 v[224:225], v[100:101], v[12:13], v[224:225] op_sel:[0,1,0] op_sel_hi:[1,1,1]
    v_pk_fma_f32 v[226:227], v[102:103], v[12:13], v[226:227] op_sel:[0,1,0] op_sel_hi:[1,1,1]
    ds_read_b64_tr_b16 a[66:67], v3 offset:16896
    v_pk_mul_f32 v[236:237], v[232:233], v[232:233]
    v_pk_mul_f32 v[238:239], v[234:235], v[234:235]
    v_pk_mul_f32 v[228:229], v[224:225], v[224:225]
    v_pk_mul_f32 v[230:231], v[226:227], v[226:227]
    ds_read_b64_tr_b16 a[68:69], v4 offset:16384
    v_pk_fma_f32 v[236:237], v[236:237], s[74:75], v[16:17] op_sel_hi:[1,0,0]
    v_pk_fma_f32 v[238:239], v[238:239], s[74:75], v[16:17] op_sel_hi:[1,0,0]
    v_pk_fma_f32 v[228:229], v[228:229], s[74:75], v[16:17] op_sel_hi:[1,0,0]
    v_pk_fma_f32 v[230:231], v[230:231], s[74:75], v[16:17] op_sel_hi:[1,0,0]
    ds_read_b64_tr_b16 a[70:71], v4 offset:16896
    v_pk_mul_f32 v[236:237], v[236:237], v[232:233]
    v_pk_mul_f32 v[238:239], v[238:239], v[234:235]
    v_pk_mul_f32 v[228:229], v[228:229], v[224:225]
    v_pk_mul_f32 v[230:231], v[230:231], v[226:227]
    ds_read_b64_tr_b16 a[72:73], v3 offset:18432
    v_exp_f32 v236, v236
    v_exp_f32 v237, v237
    v_exp_f32 v238, v238
    v_exp_f32 v239, v239
    ds_read_b64_tr_b16 a[74:75], v3 offset:18944
    v_exp_f32 v228, v228
    v_exp_f32 v229, v229
    v_exp_f32 v230, v230
    v_exp_f32 v231, v231
    ds_read_b64_tr_b16 a[76:77], v4 offset:18432
    v_pk_add_f32 v[236:237], v[236:237], 1.0 op_sel_hi:[1,0]
    v_pk_add_f32 v[238:239], v[238:239], 1.0 op_sel_hi:[1,0]
    v_pk_add_f32 v[228:229], v[228:229], 1.0 op_sel_hi:[1,0]
    v_pk_add_f32 v[230:231], v[230:231], 1.0 op_sel_hi:[1,0]
    ds_read_b64_tr_b16 a[78:79], v4 offset:18944
    v_rcp_f32 v236, v236
    v_rcp_f32 v237, v237
    v_rcp_f32 v238, v238
    v_rcp_f32 v239, v239
    s_add_u32 s64, s63, 296064
    buffer_load_short_d16_hi v246, v220, s[8:11], s64 offen offset:2
    buffer_load_short_d16_hi v254, v220, s[12:15], s64 offen offset:2
    v_rcp_f32 v228, v228
    v_rcp_f32 v229, v229
    v_rcp_f32 v230, v230
    v_rcp_f32 v231, v231
    s_add_u32 s64, s63, 312512
    buffer_load_short_d16_hi v247, v220, s[8:11], s64 offen offset:2
    buffer_load_short_d16_hi v255, v220, s[12:15], s64 offen offset:2
    v_pk_mul_f32 v[232:233], v[232:233], v[236:237]
    v_pk_mul_f32 v[234:235], v[234:235], v[238:239]
    v_pk_mul_f32 v[224:225], v[224:225], v[228:229]
    v_pk_mul_f32 v[226:227], v[226:227], v[230:231]
    v_cvt_pk_bf16_f32 v96, v232, v233
    v_cvt_pk_bf16_f32 v97, v234, v235
    v_cvt_pk_bf16_f32 v98, v224, v225
    v_cvt_pk_bf16_f32 v99, v226, v227
    s_nop 0
    v_permlane16_swap_b32 v96, v98
    v_permlane16_swap_b32 v97, v99
    buffer_store_dwordx4 v[96:99], v18, s[40:43], s57 offen offset:1024 sc1
    s_waitcnt lgkmcnt(8)
    v_pk_fma_f32 v[232:233], v[112:113], v[14:15], v[120:121] op_sel_hi:[1,0,1]
    v_pk_fma_f32 v[234:235], v[114:115], v[14:15], v[122:123] op_sel_hi:[1,0,1]
    v_pk_fma_f32 v[224:225], v[112:113], v[14:15], v[120:121] op_sel:[0,1,0] op_sel_hi:[1,1,1]
    v_pk_fma_f32 v[226:227], v[114:115], v[14:15], v[122:123] op_sel:[0,1,0] op_sel_hi:[1,1,1]
    v_pk_fma_f32 v[232:233], v[104:105], v[12:13], v[232:233] op_sel_hi:[1,0,1]
    s_waitcnt vmcnt(31)
    ds_read_b64_tr_b16 a[80:81], v3 offset:20480
    v_pk_fma_f32 v[234:235], v[106:107], v[12:13], v[234:235] op_sel_hi:[1,0,1]
    v_pk_fma_f32 v[224:225], v[108:109], v[12:13], v[224:225] op_sel:[0,1,0] op_sel_hi:[1,1,1]
    v_pk_fma_f32 v[226:227], v[110:111], v[12:13], v[226:227] op_sel:[0,1,0] op_sel_hi:[1,1,1]
    v_pk_mul_f32 v[236:237], v[232:233], v[232:233]
    v_pk_mul_f32 v[238:239], v[234:235], v[234:235]
    ds_read_b64_tr_b16 a[82:83], v3 offset:20992
    v_pk_mul_f32 v[228:229], v[224:225], v[224:225]
    v_pk_mul_f32 v[230:231], v[226:227], v[226:227]
    v_pk_fma_f32 v[236:237], v[236:237], s[74:75], v[16:17] op_sel_hi:[1,0,0]
    v_pk_fma_f32 v[238:239], v[238:239], s[74:75], v[16:17] op_sel_hi:[1,0,0]
    v_pk_fma_f32 v[228:229], v[228:229], s[74:75], v[16:17] op_sel_hi:[1,0,0]
    ds_read_b64_tr_b16 a[84:85], v4 offset:20480
    v_pk_fma_f32 v[230:231], v[230:231], s[74:75], v[16:17] op_sel_hi:[1,0,0]
    v_pk_mul_f32 v[236:237], v[236:237], v[232:233]
    v_pk_mul_f32 v[238:239], v[238:239], v[234:235]
    v_pk_mul_f32 v[228:229], v[228:229], v[224:225]
    v_pk_mul_f32 v[230:231], v[230:231], v[226:227]
    ds_read_b64_tr_b16 a[86:87], v4 offset:20992
    v_exp_f32 v236, v236
    v_exp_f32 v237, v237
    v_exp_f32 v238, v238
    v_exp_f32 v239, v239
    v_exp_f32 v228, v228
    ds_read_b64_tr_b16 a[88:89], v3 offset:22528
    v_exp_f32 v229, v229
    v_exp_f32 v230, v230
    v_exp_f32 v231, v231
    v_pk_add_f32 v[236:237], v[236:237], 1.0 op_sel_hi:[1,0]
    v_pk_add_f32 v[238:239], v[238:239], 1.0 op_sel_hi:[1,0]
    ds_read_b64_tr_b16 a[90:91], v3 offset:23040
    v_pk_add_f32 v[228:229], v[228:229], 1.0 op_sel_hi:[1,0]
    v_pk_add_f32 v[230:231], v[230:231], 1.0 op_sel_hi:[1,0]
    v_rcp_f32 v236, v236
    v_rcp_f32 v237, v237
    v_rcp_f32 v238, v238
    ds_read_b64_tr_b16 a[92:93], v4 offset:22528
    v_rcp_f32 v239, v239
    v_rcp_f32 v228, v228
    v_rcp_f32 v229, v229
    v_rcp_f32 v230, v230
    v_rcp_f32 v231, v231
    ds_read_b64_tr_b16 a[94:95], v4 offset:23040
    v_pk_mul_f32 v[232:233], v[232:233], v[236:237]
    v_pk_mul_f32 v[234:235], v[234:235], v[238:239]
    v_pk_mul_f32 v[224:225], v[224:225], v[228:229]
    v_pk_mul_f32 v[226:227], v[226:227], v[230:231]
    v_cvt_pk_bf16_f32 v104, v232, v233
    v_cmp_ne_u32 vcc, 1, v7
    s_cbranch_vccnz SPIN_z
BACK_z:
    s_lshl_b32 s69, s48, 5
    s_add_u32 s69, s69, s62
    s_lshl_b32 s69, s69, 12
    s_add_u32 s69, s69, 8388608
    buffer_load_dwordx4 a[224:227], v18, s[40:43], s69 offen offset:0 sc1
    buffer_load_dwordx4 a[228:231], v18, s[40:43], s69 offen offset:1024 sc1
    buffer_load_dwordx4 a[232:235], v18, s[40:43], s69 offen offset:2048 sc1
    buffer_load_dwordx4 a[236:239], v18, s[40:43], s69 offen offset:3072 sc1
    v_cvt_pk_bf16_f32 v105, v234, v235
    v_cvt_pk_bf16_f32 v106, v224, v225
    v_cvt_pk_bf16_f32 v107, v226, v227
    s_nop 0
    v_permlane16_swap_b32 v104, v106
    v_permlane16_swap_b32 v105, v107
    buffer_store_dwordx4 v[104:107], v18, s[40:43], s57 offen offset:2048 sc1
    s_lshl_b32 s54, s44, 4
    v_add_u32 v224, s54, v1
    v_cvt_f32_u32 v224, v224
    v_mul_f32 v225, 0x3c800000, v224
    v_mul_f32 v224, 0x3a000000, v224
    v_lshlrev_b32 v226, 7, v2
    v_add_u32 v226, s47, v226
    v_cvt_f32_u32 v226, v226
    v_mul_f32 v226, v226, v224
    v_cos_f32 v227, v226
    v_sin_f32 v228, v226
    v_add_f32 v226, v226, v225
    v_cvt_pk_bf16_f32 v192, v227, -v228
    v_cvt_pk_bf16_f32 v200, v228, v227
    v_cos_f32 v227, v226
    v_sin_f32 v228, v226
    v_add_f32 v226, v226, v225
    v_cvt_pk_bf16_f32 v193, v227, -v228
    v_cvt_pk_bf16_f32 v201, v228, v227
    v_cos_f32 v227, v226
    v_sin_f32 v228, v226
    v_add_f32 v226, v226, v225
    v_cvt_pk_bf16_f32 v194, v227, -v228
    v_cvt_pk_bf16_f32 v202, v228, v227
    v_cos_f32 v227, v226
    v_sin_f32 v228, v226
    v_fmamk_f32 v226, v225, 0x41500000, v226
    v_cvt_pk_bf16_f32 v195, v227, -v228
    v_cvt_pk_bf16_f32 v203, v228, v227
    v_cos_f32 v227, v226
    v_sin_f32 v228, v226
    v_add_f32 v226, v226, v225
    v_cvt_pk_bf16_f32 v196, v227, -v228
    v_cvt_pk_bf16_f32 v204, v228, v227
    v_cos_f32 v227, v226
    v_sin_f32 v228, v226
    v_add_f32 v226, v226, v225
    v_cvt_pk_bf16_f32 v197, v227, -v228
    v_cvt_pk_bf16_f32 v205, v228, v227
    v_cos_f32 v227, v226
    v_sin_f32 v228, v226
    v_add_f32 v226, v226, v225
    v_cvt_pk_bf16_f32 v198, v227, -v228
    v_cvt_pk_bf16_f32 v206, v228, v227
    v_cos_f32 v227, v226
    v_sin_f32 v228, v226
    s_nop 0
    v_cvt_pk_bf16_f32 v199, v227, -v228
    v_cvt_pk_bf16_f32 v207, v228, v227
    v_lshlrev_b32 v226, 7, v2
    v_add_u32 v226, s61, v226
    v_cvt_f32_u32 v226, v226
    v_mul_f32 v226, v226, v224
    v_cos_f32 v227, v226
    v_sin_f32 v228, v226
    v_add_f32 v226, v226, v225
    v_cvt_pk_bf16_f32 v208, v227, -v228
    v_cvt_pk_bf16_f32 v216, v228, v227
    v_cos_f32 v227, v226
    v_sin_f32 v228, v226
    v_add_f32 v226, v226, v225
    v_cvt_pk_bf16_f32 v209, v227, -v228
    v_cvt_pk_bf16_f32 v217, v228, v227
    v_cos_f32 v227, v226
    v_sin_f32 v228, v226
    v_add_f32 v226, v226, v225
    v_cvt_pk_bf16_f32 v210, v227, -v228
    v_cvt_pk_bf16_f32 v218, v228, v227
    v_cos_f32 v227, v226
    v_sin_f32 v228, v226
    v_fmamk_f32 v226, v225, 0x41500000, v226
    v_cvt_pk_bf16_f32 v211, v227, -v228
    v_cvt_pk_bf16_f32 v219, v228, v227
    v_cos_f32 v227, v226
    v_sin_f32 v228, v226
    v_add_f32 v226, v226, v225
    v_cvt_pk_bf16_f32 v212, v227, -v228
    v_cvt_pk_bf16_f32 v220, v228, v227
    v_cos_f32 v227, v226
    v_sin_f32 v228, v226
    v_add_f32 v226, v226, v225
    v_cvt_pk_bf16_f32 v213, v227, -v228
    v_cvt_pk_bf16_f32 v221, v228, v227
    v_cos_f32 v227, v226
    v_sin_f32 v228, v226
    v_add_f32 v226, v226, v225
    v_cvt_pk_bf16_f32 v214, v227, -v228
    v_cvt_pk_bf16_f32 v222, v228, v227
    v_cos_f32 v227, v226
    v_sin_f32 v228, v226
    s_nop 0
    v_cvt_pk_bf16_f32 v215, v227, -v228
    v_cvt_pk_bf16_f32 v223, v228, v227
    s_lshr_b32 s52, s44, 1
    s_lshl1_add_u32 s52, s49, s52
    s_xor_b32 s53, s52, 1
    s_mul_i32 s54, s44, 28672
    s_mul_i32 s52, s52, 114688
    s_mul_i32 s53, s53, 114688
    s_add_u32 s52, s52, s54
    s_add_u32 s53, s53, s54
    v_lshlrev_b32 v224, 4, v0
    v_add_u32 v10, s52, v224
    v_add_u32 v11, s53, v224
    s_lshl2_add_u32 s56, s45, s44
    s_lshl4_add_u32 s56, s56, s46
    s_lshl2_add_u32 s56, s56, 12587008
    s_waitcnt vmcnt(0)
    buffer_store_dword v8, v5, s[40:43], s56 offen sc1
    v_and_b32 v232, 31, v0
    v_cvt_f32_u32 v232, v232
    v_lshrrev_b32 v233, 5, v0
    v_cvt_f32_u32 v233, v233
    v_mul_f32 v232, 0x3d000000, v232
    v_add_f32 v233, v233, v233
    v_mul_f32 v233, v233, v232
    v_sin_f32 v235, v233
    v_and_b32 v234, 1, v0
    v_lshlrev_b32 v234, 31, v234
    v_xor_b32 v234, -1.0, v234
    v_cmp_gt_u32 s[76:77], 32, v0
    s_nop 1
    v_cndmask_b32 v235, v235, v234, s[76:77]
    v_cos_f32 v234, v233
    s_nop 0
    v_cvt_pk_bf16_f32 v40, v234, -v235
    v_fmamk_f32 v234, v232, 0x3f800000, v233
    v_sin_f32 v235, v234
    v_cos_f32 v234, v234
    s_nop 0
    v_cvt_pk_bf16_f32 v41, v234, -v235
    v_fmamk_f32 v234, v232, 0x41000000, v233
    v_sin_f32 v235, v234
    v_cos_f32 v234, v234
    s_nop 0
    v_cvt_pk_bf16_f32 v42, v234, -v235
    v_fmamk_f32 v234, v232, 0x41100000, v233
    v_sin_f32 v235, v234
    v_cos_f32 v234, v234
    s_nop 0
    v_cvt_pk_bf16_f32 v43, v234, -v235
    v_fmamk_f32 v234, v232, 0x40800000, v233
    v_sin_f32 v235, v234
    v_cos_f32 v234, v234
    s_nop 0
    v_cvt_pk_bf16_f32 v44, v234, -v235
    v_fmamk_f32 v234, v232, 0x40a00000, v233
    v_sin_f32 v235, v234
    v_cos_f32 v234, v234
    s_nop 0
    v_cvt_pk_bf16_f32 v45, v234, -v235
    v_fmamk_f32 v234, v232, 0x41400000, v233
    v_sin_f32 v235, v234
    v_cos_f32 v234, v234
    s_nop 0
    v_cvt_pk_bf16_f32 v46, v234, -v235
    v_fmamk_f32 v234, v232, 0x41500000, v233
    v_sin_f32 v235, v234
    v_cos_f32 v234, v234
    s_nop 0
    v_cvt_pk_bf16_f32 v47, v234, -v235
    v_mfma_f32_16x16x32_bf16 v[24:27], v[128:131], a[224:227], 0
    v_mfma_f32_16x16x32_bf16 v[28:31], v[144:147], a[224:227], 0
    s_add_u32 s67, s65, 16384
    s_cmp_ge_u32 s67, 28672
    s_cselect_b32 s53, 28672, 0
    s_sub_u32 s67, s67, s53
    s_lshl_b32 s67, s67, 4
    s_add_u32 m0, s66, 0
    s_nop 0
    buffer_load_dwordx4 v49, s[24:27], s67 offen offset:0 lds
    v_mfma_f32_16x16x32_bf16 v[32:35], v[160:163], a[224:227], 0
    v_mfma_f32_16x16x32_bf16 v[36:39], v[176:179], a[224:227], 0
    buffer_load_dwordx4 v50, s[24:27], s67 offen offset:1024 lds
    v_mfma_f32_16x16x32_bf16 v[24:27], v[132:135], a[228:231], v[24:27]
    v_mfma_f32_16x16x32_bf16 v[28:31], v[148:151], a[228:231], v[28:31]
    buffer_load_dwordx4 v51, s[24:27], s67 offen offset:2048 lds
    v_mfma_f32_16x16x32_bf16 v[32:35], v[164:167], a[228:231], v[32:35]
    v_mfma_f32_16x16x32_bf16 v[36:39], v[180:183], a[228:231], v[36:39]
    buffer_load_dwordx4 v52, s[24:27], s67 offen offset:3072 lds
    v_mfma_f32_16x16x32_bf16 v[24:27], v[136:139], a[232:235], v[24:27]
    v_mfma_f32_16x16x32_bf16 v[28:31], v[152:155], a[232:235], v[28:31]
    s_add_u32 s67, s65, 18432
    s_cmp_ge_u32 s67, 28672
    s_cselect_b32 s53, 28672, 0
    s_sub_u32 s67, s67, s53
    s_lshl_b32 s67, s67, 4
    s_add_u32 m0, s66, 4096
    s_nop 0
    buffer_load_dwordx4 v49, s[24:27], s67 offen offset:0 lds
    v_mfma_f32_16x16x32_bf16 v[32:35], v[168:171], a[232:235], v[32:35]
    v_mfma_f32_16x16x32_bf16 v[36:39], v[184:187], a[232:235], v[36:39]
    buffer_load_dwordx4 v50, s[24:27], s67 offen offset:1024 lds
    v_mfma_f32_16x16x32_bf16 v[24:27], v[140:143], a[236:239], v[24:27]
    v_mfma_f32_16x16x32_bf16 v[28:31], v[156:159], a[236:239], v[28:31]
    buffer_load_dwordx4 v51, s[24:27], s67 offen offset:2048 lds
    v_mfma_f32_16x16x32_bf16 v[32:35], v[172:175], a[236:239], v[32:35]
    v_mfma_f32_16x16x32_bf16 v[36:39], v[188:191], a[236:239], v[36:39]
    buffer_load_dwordx4 v52, s[24:27], s67 offen offset:3072 lds
    s_lshl_b32 s52, s44, 11
    s_add_u32 s52, s52, 135168
    v_add_u32 v16, s52, v18
    v_add_u32 v17, 135168, v18
    v_cmp_u_f32 vcc, v24, v24
    s_cbranch_vccnz ZRETRY
ZBACK:
    v_pk_mul_f32 v[224:225], v[24:25], v[240:241]
    v_pk_mul_f32 v[228:229], v[24:25], v[248:249]
    v_pk_mul_f32 v[226:227], v[26:27], v[242:243]
    v_pk_mul_f32 v[230:231], v[26:27], v[250:251]
    v_pk_fma_f32 v[224:225], v[28:29], v[248:249], v[224:225] neg_lo:[1,0,0] neg_hi:[1,0,0]
    v_pk_fma_f32 v[228:229], v[28:29], v[240:241], v[228:229]
    v_pk_fma_f32 v[226:227], v[30:31], v[250:251], v[226:227] neg_lo:[1,0,0] neg_hi:[1,0,0]
    v_pk_fma_f32 v[230:231], v[30:31], v[242:243], v[230:231]
    v_cvt_pk_bf16_f32 v232, v224, v228
    v_cvt_pk_bf16_f32 v233, v225, v229
    v_cvt_pk_bf16_f32 v234, v226, v230
    v_cvt_pk_bf16_f32 v235, v227, v231
    ds_write_b128 v16, v[232:235] offset:0
    v_pk_mul_f32 v[224:225], v[32:33], v[244:245]
    v_pk_mul_f32 v[228:229], v[32:33], v[252:253]
    v_pk_mul_f32 v[226:227], v[34:35], v[246:247]
    v_pk_mul_f32 v[230:231], v[34:35], v[254:255]
    v_pk_fma_f32 v[224:225], v[36:37], v[252:253], v[224:225] neg_lo:[1,0,0] neg_hi:[1,0,0]
    v_pk_fma_f32 v[228:229], v[36:37], v[244:245], v[228:229]
    v_pk_fma_f32 v[226:227], v[38:39], v[254:255], v[226:227] neg_lo:[1,0,0] neg_hi:[1,0,0]
    v_pk_fma_f32 v[230:231], v[38:39], v[246:247], v[230:231]
    v_cvt_pk_bf16_f32 v236, v224, v228
    v_cvt_pk_bf16_f32 v237, v225, v229
    v_cvt_pk_bf16_f32 v238, v226, v230
    v_cvt_pk_bf16_f32 v239, v227, v231
    ds_write_b128 v16, v[236:239] offset:1024
    s_waitcnt lgkmcnt(0)
    s_barrier
    ds_read_b128 a[224:227], v17 offset:0
    ds_read_b128 a[228:231], v17 offset:1024
    ds_read_b128 a[232:235], v17 offset:2048
    ds_read_b128 a[236:239], v17 offset:3072
    ds_read_b128 a[240:243], v17 offset:4096
    ds_read_b128 a[244:247], v17 offset:5120
    ds_read_b128 a[248:251], v17 offset:6144
    ds_read_b128 a[252:255], v17 offset:7168
    v_mov_b32 v248, v19
    v_mov_b32 v252, 0x3f80
    v_mov_b32 v249, 0
    v_mov_b32 v250, 0
    v_mov_b32 v251, 0
    v_mov_b32 v253, 0
    v_mov_b32 v254, 0
    v_mov_b32 v255, 0
    s_waitcnt lgkmcnt(7)
    v_mfma_f32_16x16x32_bf16 v[128:131], a[224:227], v[192:195], 0
    v_mfma_f32_16x16x32_bf16 v[136:139], a[224:227], v[200:203], 0
    s_waitcnt lgkmcnt(6)
    v_mfma_f32_16x16x32_bf16 v[128:131], a[228:231], v[196:199], v[128:131]
    v_mfma_f32_16x16x32_bf16 v[136:139], a[228:231], v[204:207], v[136:139]
    s_waitcnt lgkmcnt(5)
    v_mfma_f32_16x16x32_bf16 v[132:135], a[232:235], v[192:195], 0
    v_mfma_f32_16x16x32_bf16 v[140:143], a[232:235], v[200:203], 0
    s_waitcnt lgkmcnt(4)
    v_mfma_f32_16x16x32_bf16 v[132:135], a[236:239], v[196:199], v[132:135]
    v_mfma_f32_16x16x32_bf16 v[140:143], a[236:239], v[204:207], v[140:143]
    s_waitcnt lgkmcnt(3)
    v_mfma_f32_16x16x32_bf16 v[144:147], a[240:243], v[208:211], 0
    v_mfma_f32_16x16x32_bf16 v[152:155], a[240:243], v[216:219], 0
    s_waitcnt lgkmcnt(2)
    v_mfma_f32_16x16x32_bf16 v[144:147], a[244:247], v[212:215], v[144:147]
    v_mfma_f32_16x16x32_bf16 v[152:155], a[244:247], v[220:223], v[152:155]
    s_waitcnt lgkmcnt(1)
    v_mfma_f32_16x16x32_bf16 v[148:151], a[248:251], v[208:211], 0
    v_mfma_f32_16x16x32_bf16 v[156:159], a[248:251], v[216:219], 0
    s_waitcnt lgkmcnt(0)
    v_mfma_f32_16x16x32_bf16 v[148:151], a[252:255], v[212:215], v[148:151]
    v_mfma_f32_16x16x32_bf16 v[156:159], a[252:255], v[220:223], v[156:159]
    v_and_b32 v160, 1, v1
    v_lshlrev_b32 v160, 31, v160
    v_or_b32 v160, 1.0, v160
    s_lshl_b32 s52, s44, 8
    s_add_u32 s52, s52, s48
    s_lshl_b32 s52, s52, 4
    s_add_u32 s52, s52, s47
    s_lshl_b32 s52, s52, 7
    s_add_u32 s64, s52, 10485760
    v_lshlrev_b32 v162, 15, v1
    v_lshl_add_u32 v162, v2, 4, v162
    v_pk_fma_f32 v[128:129], v[132:133], v[160:161], v[128:129] op_sel_hi:[1,0,1]
    v_pk_fma_f32 v[130:131], v[134:135], v[160:161], v[130:131] op_sel_hi:[1,0,1]
    v_pk_fma_f32 v[136:137], v[140:141], v[160:161], v[136:137] op_sel_hi:[1,0,1]
    v_pk_fma_f32 v[138:139], v[142:143], v[160:161], v[138:139] op_sel_hi:[1,0,1]
    v_pk_fma_f32 v[144:145], v[148:149], v[160:161], v[144:145] op_sel_hi:[1,0,1]
    v_pk_fma_f32 v[146:147], v[150:151], v[160:161], v[146:147] op_sel_hi:[1,0,1]
    v_pk_fma_f32 v[152:153], v[156:157], v[160:161], v[152:153] op_sel_hi:[1,0,1]
    v_pk_fma_f32 v[154:155], v[158:159], v[160:161], v[154:155] op_sel_hi:[1,0,1]
    s_cmp_eq_u32 s47, 0
    s_cbranch_scc1 CP0
    v_pk_add_f32 v[132:133], v[136:137], v[152:153] neg_lo:[0,1] neg_hi:[0,1]
    v_pk_add_f32 v[136:137], v[136:137], v[152:153]
    v_pk_add_f32 v[152:153], v[144:145], v[128:129] neg_lo:[0,1] neg_hi:[0,1]
    v_pk_add_f32 v[128:129], v[128:129], v[144:145]
    v_mov_b32 v144, v132
    v_mov_b32 v145, v133
    v_pk_add_f32 v[134:135], v[138:139], v[154:155] neg_lo:[0,1] neg_hi:[0,1]
    v_pk_add_f32 v[138:139], v[138:139], v[154:155]
    v_pk_add_f32 v[154:155], v[146:147], v[130:131] neg_lo:[0,1] neg_hi:[0,1]
    v_pk_add_f32 v[130:131], v[130:131], v[146:147]
    v_mov_b32 v146, v134
    v_mov_b32 v147, v135
CP0:
    v_cvt_pk_bf16_f32 v164, v128, v129
    v_cvt_pk_bf16_f32 v165, v130, v131
    v_cvt_pk_bf16_f32 v166, v136, v137
    v_cvt_pk_bf16_f32 v167, v138, v139
    buffer_store_dwordx4 v[164:167], v162, s[40:43], s64 offen offset:0 sc1
    v_cvt_pk_bf16_f32 v168, v144, v145
    v_cvt_pk_bf16_f32 v169, v146, v147
    v_cvt_pk_bf16_f32 v170, v152, v153
    v_cvt_pk_bf16_f32 v171, v154, v155
    buffer_store_dwordx4 v[168:171], v162, s[40:43], s64 offen offset:64 sc1
    s_lshl_b32 s54, s44, 6
    s_add_u32 s54, s54, 1
    v_lshlrev_b32 v21, 2, v2
    v_add_u32 v21, s54, v21
    v_cvt_f32_u32 v21, v21
    s_lshl_b32 s54, s50, 6
    v_add_u32 v20, s54, v1
    v_cvt_f32_u32 v20, v20
    v_mul_f32 v20, 0x3b000000, v20
    v_mul_f32 v23, 0x41800000, v20
    s_add_u32 s67, s65, 20480
    s_cmp_ge_u32 s67, 28672
    s_cselect_b32 s53, 28672, 0
    s_sub_u32 s67, s67, s53
    s_lshl_b32 s67, s67, 4
    s_add_u32 m0, s66, 8192
    s_nop 0
    buffer_load_dwordx4 v49, s[24:27], s67 offen offset:0 lds
    v_mul_f32 v22, 0x3d000000, v21
    v_cos_f32 v23, v23
    v_cos_f32 v172, v22
    v_add_f32 v22, 0x3d000000, v22
    v_cos_f32 v173, v22
    v_add_f32 v22, 0x3d000000, v22
    v_cos_f32 v174, v22
    buffer_load_dwordx4 v50, s[24:27], s67 offen offset:1024 lds
    v_add_f32 v22, 0x3d000000, v22
    v_cos_f32 v175, v22
    v_add_f32 v23, v23, v23
    v_mul_f32 v22, v20, v21
    v_pk_add_f32 v[172:173], v[172:173], v[172:173]
    v_pk_add_f32 v[174:175], v[174:175], v[174:175]
    v_cos_f32 v120, v22
    buffer_load_dwordx4 v51, s[24:27], s67 offen offset:2048 lds
    v_sin_f32 v124, v22
    v_add_f32 v22, v22, v20
    v_cos_f32 v121, v22
    v_sin_f32 v125, v22
    v_add_f32 v22, v22, v20
    v_cos_f32 v122, v22
    v_sin_f32 v126, v22
    buffer_load_dwordx4 v52, s[24:27], s67 offen offset:3072 lds
    v_add_f32 v22, v22, v20
    v_cos_f32 v123, v22
    v_sin_f32 v127, v22
    v_fmamk_f32 v22, v20, 0x41500000, v22
    v_cvt_pk_bf16_f32 v56, v120, v121
    v_cvt_pk_bf16_f32 v57, v122, v123
    v_cvt_pk_bf16_f32 v58, -v124, -v125
    s_lshl_b32 s60, s49, 7
    s_lshl4_add_u32 s60, s44, s60
    s_add_u32 s60, s60, 12587008
    v_and_b32 v6, 0x13, v0
    v_lshlrev_b32 v6, 2, v6
    buffer_load_dword v7, v6, s[40:43], s60 offen sc1
    v_cvt_pk_bf16_f32 v59, -v126, -v127
    v_cos_f32 v128, v22
    v_sin_f32 v132, v22
    v_add_f32 v22, v22, v20
    v_cos_f32 v129, v22
    v_sin_f32 v133, v22
    v_add_f32 v22, v22, v20
    s_add_u32 s67, s65, 22528
    s_cmp_ge_u32 s67, 28672
    s_cselect_b32 s53, 28672, 0
    s_sub_u32 s67, s67, s53
    s_lshl_b32 s67, s67, 4
    s_add_u32 m0, s66, 12288
    s_nop 0
    buffer_load_dwordx4 v49, s[24:27], s67 offen offset:0 lds
    v_cos_f32 v130, v22
    v_sin_f32 v134, v22
    v_add_f32 v22, v22, v20
    v_cos_f32 v131, v22
    v_sin_f32 v135, v22
    v_add_f32 v20, 0x3d000000, v20
    v_cvt_pk_bf16_f32 v72, v128, v129
    buffer_load_dwordx4 v50, s[24:27], s67 offen offset:1024 lds
    v_cvt_pk_bf16_f32 v73, v130, v131
    v_cvt_pk_bf16_f32 v74, -v132, -v133
    v_cvt_pk_bf16_f32 v75, -v134, -v135
    v_pk_fma_f32 v[152:153], v[22:23], v[128:129], v[120:121] op_sel:[1,0,0] op_sel_hi:[1,1,1] neg_lo:[0,0,1] neg_hi:[0,0,1]
    v_pk_fma_f32 v[154:155], v[22:23], v[130:131], v[122:123] op_sel:[1,0,0] op_sel_hi:[1,1,1] neg_lo:[0,0,1] neg_hi:[0,0,1]
    v_pk_fma_f32 v[156:157], v[22:23], v[132:133], v[124:125] op_sel:[1,0,0] op_sel_hi:[1,1,1] neg_lo:[0,0,1] neg_hi:[0,0,1]
    v_pk_fma_f32 v[158:159], v[22:23], v[134:135], v[126:127] op_sel:[1,0,0] op_sel_hi:[1,1,1] neg_lo:[0,0,1] neg_hi:[0,0,1]
    buffer_load_dwordx4 v51, s[24:27], s67 offen offset:2048 lds
    v_cvt_pk_bf16_f32 v88, v152, v153
    v_cvt_pk_bf16_f32 v89, v154, v155
    v_cvt_pk_bf16_f32 v90, -v156, -v157
    v_cvt_pk_bf16_f32 v91, -v158, -v159
    v_pk_fma_f32 v[152:153], v[22:23], v[152:153], v[128:129] op_sel:[1,0,0] op_sel_hi:[1,1,1] neg_lo:[0,0,1] neg_hi:[0,0,1]
    v_pk_fma_f32 v[154:155], v[22:23], v[154:155], v[130:131] op_sel:[1,0,0] op_sel_hi:[1,1,1] neg_lo:[0,0,1] neg_hi:[0,0,1]
    v_pk_fma_f32 v[156:157], v[22:23], v[156:157], v[132:133] op_sel:[1,0,0] op_sel_hi:[1,1,1] neg_lo:[0,0,1] neg_hi:[0,0,1]
    buffer_load_dwordx4 v52, s[24:27], s67 offen offset:3072 lds
    v_pk_fma_f32 v[158:159], v[22:23], v[158:159], v[134:135] op_sel:[1,0,0] op_sel_hi:[1,1,1] neg_lo:[0,0,1] neg_hi:[0,0,1]
    v_cvt_pk_bf16_f32 v104, v152, v153
    v_cvt_pk_bf16_f32 v105, v154, v155
    v_cvt_pk_bf16_f32 v106, -v156, -v157
    s_lshl4_add_u32 s56, s44, s48
    s_lshl4_add_u32 s56, s56, s47
    s_lshl2_add_u32 s56, s56, 12591104
    s_waitcnt vmcnt(9)
    buffer_store_dword v8, v5, s[40:43], s56 offen sc1
    v_cvt_pk_bf16_f32 v107, -v158, -v159
    v_mul_f32 v22, v20, v21
    s_add_u32 s67, s65, 24576
    s_cmp_ge_u32 s67, 28672
    s_cselect_b32 s53, 28672, 0
    s_sub_u32 s67, s67, s53
    s_lshl_b32 s67, s67, 4
    s_add_u32 m0, s66, 16384
    s_nop 0
    buffer_load_dwordx4 v49, s[24:27], s67 offen offset:0 lds
    v_cos_f32 v136, v22
    v_sin_f32 v140, v22
    buffer_load_dwordx4 v50, s[24:27], s67 offen offset:1024 lds
    v_add_f32 v22, v22, v20
    v_cos_f32 v137, v22
    buffer_load_dwordx4 v51, s[24:27], s67 offen offset:2048 lds
    v_sin_f32 v141, v22
    v_add_f32 v22, v22, v20
    buffer_load_dwordx4 v52, s[24:27], s67 offen offset:3072 lds
    v_cos_f32 v138, v22
    v_sin_f32 v142, v22
    s_add_u32 s67, s65, 26624
    s_cmp_ge_u32 s67, 28672
    s_cselect_b32 s53, 28672, 0
    s_sub_u32 s67, s67, s53
    s_lshl_b32 s67, s67, 4
    s_add_u32 m0, s66, 20480
    s_nop 0
    buffer_load_dwordx4 v49, s[24:27], s67 offen offset:0 lds
    v_add_f32 v22, v22, v20
    v_cos_f32 v139, v22
    buffer_load_dwordx4 v50, s[24:27], s67 offen offset:1024 lds
    v_sin_f32 v143, v22
    v_fmamk_f32 v22, v20, 0x41500000, v22
    buffer_load_dwordx4 v51, s[24:27], s67 offen offset:2048 lds
    v_cvt_pk_bf16_f32 v60, v136, v137
    v_cvt_pk_bf16_f32 v61, v138, v139
    buffer_load_dwordx4 v52, s[24:27], s67 offen offset:3072 lds
    v_cvt_pk_bf16_f32 v62, -v140, -v141
    v_cvt_pk_bf16_f32 v63, -v142, -v143
    v_cos_f32 v144, v22
    v_sin_f32 v148, v22
    v_add_f32 v22, v22, v20
    v_cos_f32 v145, v22
    v_sin_f32 v149, v22
    v_add_f32 v22, v22, v20
    v_cos_f32 v146, v22
    v_sin_f32 v150, v22
    v_add_f32 v22, v22, v20
    v_cos_f32 v147, v22
    v_sin_f32 v151, v22
    v_cvt_pk_bf16_f32 v76, v144, v145
    v_cvt_pk_bf16_f32 v77, v146, v147
    v_cvt_pk_bf16_f32 v78, -v148, -v149
    v_cvt_pk_bf16_f32 v79, -v150, -v151
    v_pk_fma_f32 v[152:153], v[22:23], v[144:145], v[136:137] op_sel:[1,0,0] op_sel_hi:[1,1,1] neg_lo:[1,0,1] neg_hi:[1,0,1]
    v_pk_fma_f32 v[154:155], v[22:23], v[146:147], v[138:139] op_sel:[1,0,0] op_sel_hi:[1,1,1] neg_lo:[1,0,1] neg_hi:[1,0,1]
    v_pk_fma_f32 v[156:157], v[22:23], v[148:149], v[140:141] op_sel:[1,0,0] op_sel_hi:[1,1,1] neg_lo:[1,0,1] neg_hi:[1,0,1]
    v_pk_fma_f32 v[158:159], v[22:23], v[150:151], v[142:143] op_sel:[1,0,0] op_sel_hi:[1,1,1] neg_lo:[1,0,1] neg_hi:[1,0,1]
    v_cvt_pk_bf16_f32 v92, v152, v153
    v_cvt_pk_bf16_f32 v93, v154, v155
    v_cvt_pk_bf16_f32 v94, -v156, -v157
    s_waitcnt vmcnt(13)
    v_cmp_ne_u32 vcc, 1, v7
    s_cbranch_vccnz SPIN_h
BACK_h:
    s_add_u32 s68, s65, 0
    s_cmp_ge_u32 s68, 28672
    s_cselect_b32 s53, 28672, 0
    s_sub_u32 s68, s68, s53
    buffer_load_dwordx4 v[224:227], v10, s[40:43], s68 offen offset:0 sc1
    buffer_load_dwordx4 v[228:231], v11, s[40:43], s68 offen offset:0 sc1
    buffer_load_dwordx4 v[232:235], v10, s[40:43], s68 offen offset:1024 sc1
    buffer_load_dwordx4 v[236:239], v11, s[40:43], s68 offen offset:1024 sc1
    s_add_u32 s73, s65, 2048
    s_cmp_ge_u32 s73, 28672
    s_cselect_b32 s53, 28672, 0
    s_sub_u32 s73, s73, s53
    buffer_load_dwordx4 v[240:243], v10, s[40:43], s73 offen offset:0 sc1
    buffer_load_dwordx4 v[244:247], v11, s[40:43], s73 offen offset:0 sc1
    buffer_load_dwordx4 v[184:187], v10, s[40:43], s73 offen offset:1024 sc1
    buffer_load_dwordx4 v[188:191], v11, s[40:43], s73 offen offset:1024 sc1
    v_cvt_pk_bf16_f32 v95, -v158, -v159
    v_pk_fma_f32 v[152:153], v[22:23], v[152:153], v[144:145] op_sel:[1,0,0] op_sel_hi:[1,1,1] neg_lo:[1,0,1] neg_hi:[1,0,1]
    v_pk_fma_f32 v[154:155], v[22:23], v[154:155], v[146:147] op_sel:[1,0,0] op_sel_hi:[1,1,1] neg_lo:[1,0,1] neg_hi:[1,0,1]
    v_pk_fma_f32 v[156:157], v[22:23], v[156:157], v[148:149] op_sel:[1,0,0] op_sel_hi:[1,1,1] neg_lo:[1,0,1] neg_hi:[1,0,1]
    v_pk_fma_f32 v[158:159], v[22:23], v[158:159], v[150:151] op_sel:[1,0,0] op_sel_hi:[1,1,1] neg_lo:[1,0,1] neg_hi:[1,0,1]
    v_cvt_pk_bf16_f32 v108, v152, v153
    v_cvt_pk_bf16_f32 v109, v154, v155
    v_cvt_pk_bf16_f32 v110, -v156, -v157
    s_add_u32 s68, s65, 4096
    s_cmp_ge_u32 s68, 28672
    s_cselect_b32 s53, 28672, 0
    s_sub_u32 s68, s68, s53
    buffer_load_dwordx4 v[192:195], v10, s[40:43], s68 offen offset:0 sc1
    v_cvt_pk_bf16_f32 v111, -v158, -v159
    v_pk_fma_f32 v[120:121], v[172:173], v[136:137], v[120:121] neg_lo:[0,0,1] neg_hi:[0,0,1]
    v_pk_fma_f32 v[122:123], v[174:175], v[138:139], v[122:123] neg_lo:[0,0,1] neg_hi:[0,0,1]
    v_pk_fma_f32 v[124:125], v[172:173], v[140:141], v[124:125] neg_lo:[0,0,1] neg_hi:[0,0,1]
    v_pk_fma_f32 v[126:127], v[174:175], v[142:143], v[126:127] neg_lo:[0,0,1] neg_hi:[0,0,1]
    v_cvt_pk_bf16_f32 v64, v120, v121
    v_cvt_pk_bf16_f32 v65, v122, v123
    v_cvt_pk_bf16_f32 v66, -v124, -v125
    buffer_load_dwordx4 v[196:199], v11, s[40:43], s68 offen offset:0 sc1
    v_cvt_pk_bf16_f32 v67, -v126, -v127
    v_pk_fma_f32 v[128:129], v[172:173], v[144:145], v[128:129] neg_lo:[1,0,1] neg_hi:[1,0,1]
    v_pk_fma_f32 v[130:131], v[174:175], v[146:147], v[130:131] neg_lo:[1,0,1] neg_hi:[1,0,1]
    v_pk_fma_f32 v[132:133], v[172:173], v[148:149], v[132:133] neg_lo:[1,0,1] neg_hi:[1,0,1]
    v_pk_fma_f32 v[134:135], v[174:175], v[150:151], v[134:135] neg_lo:[1,0,1] neg_hi:[1,0,1]
    v_cvt_pk_bf16_f32 v80, v128, v129
    v_cvt_pk_bf16_f32 v81, v130, v131
    v_cvt_pk_bf16_f32 v82, -v132, -v133
    buffer_load_dwordx4 v[200:203], v10, s[40:43], s68 offen offset:1024 sc1
    v_cvt_pk_bf16_f32 v83, -v134, -v135
    v_pk_fma_f32 v[152:153], v[22:23], v[128:129], v[120:121] op_sel:[1,0,0] op_sel_hi:[1,1,1] neg_lo:[0,0,1] neg_hi:[0,0,1]
    v_pk_fma_f32 v[154:155], v[22:23], v[130:131], v[122:123] op_sel:[1,0,0] op_sel_hi:[1,1,1] neg_lo:[0,0,1] neg_hi:[0,0,1]
    v_pk_fma_f32 v[156:157], v[22:23], v[132:133], v[124:125] op_sel:[1,0,0] op_sel_hi:[1,1,1] neg_lo:[0,0,1] neg_hi:[0,0,1]
    v_pk_fma_f32 v[158:159], v[22:23], v[134:135], v[126:127] op_sel:[1,0,0] op_sel_hi:[1,1,1] neg_lo:[0,0,1] neg_hi:[0,0,1]
    v_cvt_pk_bf16_f32 v96, v152, v153
    v_cvt_pk_bf16_f32 v97, v154, v155
    v_cvt_pk_bf16_f32 v98, -v156, -v157
    buffer_load_dwordx4 v[204:207], v11, s[40:43], s68 offen offset:1024 sc1
    v_cvt_pk_bf16_f32 v99, -v158, -v159
    v_pk_fma_f32 v[152:153], v[22:23], v[152:153], v[128:129] op_sel:[1,0,0] op_sel_hi:[1,1,1] neg_lo:[0,0,1] neg_hi:[0,0,1]
    v_pk_fma_f32 v[154:155], v[22:23], v[154:155], v[130:131] op_sel:[1,0,0] op_sel_hi:[1,1,1] neg_lo:[0,0,1] neg_hi:[0,0,1]
    v_pk_fma_f32 v[156:157], v[22:23], v[156:157], v[132:133] op_sel:[1,0,0] op_sel_hi:[1,1,1] neg_lo:[0,0,1] neg_hi:[0,0,1]
    v_pk_fma_f32 v[158:159], v[22:23], v[158:159], v[134:135] op_sel:[1,0,0] op_sel_hi:[1,1,1] neg_lo:[0,0,1] neg_hi:[0,0,1]
    v_cvt_pk_bf16_f32 v112, v152, v153
    v_cvt_pk_bf16_f32 v113, v154, v155
    v_cvt_pk_bf16_f32 v114, -v156, -v157
    s_add_u32 s73, s65, 6144
    s_cmp_ge_u32 s73, 28672
    s_cselect_b32 s53, 28672, 0
    s_sub_u32 s73, s73, s53
    buffer_load_dwordx4 v[208:211], v10, s[40:43], s73 offen offset:0 sc1
    v_cvt_pk_bf16_f32 v115, -v158, -v159
    v_pk_fma_f32 v[136:137], v[172:173], v[120:121], v[136:137] neg_lo:[0,0,1] neg_hi:[0,0,1]
    v_pk_fma_f32 v[138:139], v[174:175], v[122:123], v[138:139] neg_lo:[0,0,1] neg_hi:[0,0,1]
    v_pk_fma_f32 v[140:141], v[172:173], v[124:125], v[140:141] neg_lo:[0,0,1] neg_hi:[0,0,1]
    v_pk_fma_f32 v[142:143], v[174:175], v[126:127], v[142:143] neg_lo:[0,0,1] neg_hi:[0,0,1]
    v_cvt_pk_bf16_f32 v68, v136, v137
    v_cvt_pk_bf16_f32 v69, v138, v139
    v_cvt_pk_bf16_f32 v70, -v140, -v141
    buffer_load_dwordx4 v[212:215], v11, s[40:43], s73 offen offset:0 sc1
    v_cvt_pk_bf16_f32 v71, -v142, -v143
    v_pk_fma_f32 v[144:145], v[172:173], v[128:129], v[144:145] neg_lo:[1,0,1] neg_hi:[1,0,1]
    v_pk_fma_f32 v[146:147], v[174:175], v[130:131], v[146:147] neg_lo:[1,0,1] neg_hi:[1,0,1]
    v_pk_fma_f32 v[148:149], v[172:173], v[132:133], v[148:149] neg_lo:[1,0,1] neg_hi:[1,0,1]
    v_pk_fma_f32 v[150:151], v[174:175], v[134:135], v[150:151] neg_lo:[1,0,1] neg_hi:[1,0,1]
    v_cvt_pk_bf16_f32 v84, v144, v145
    v_cvt_pk_bf16_f32 v85, v146, v147
    v_cvt_pk_bf16_f32 v86, -v148, -v149
    buffer_load_dwordx4 v[216:219], v10, s[40:43], s73 offen offset:1024 sc1
    v_cvt_pk_bf16_f32 v87, -v150, -v151
    v_pk_fma_f32 v[152:153], v[22:23], v[144:145], v[136:137] op_sel:[1,0,0] op_sel_hi:[1,1,1] neg_lo:[1,0,1] neg_hi:[1,0,1]
    v_pk_fma_f32 v[154:155], v[22:23], v[146:147], v[138:139] op_sel:[1,0,0] op_sel_hi:[1,1,1] neg_lo:[1,0,1] neg_hi:[1,0,1]
    v_pk_fma_f32 v[156:157], v[22:23], v[148:149], v[140:141] op_sel:[1,0,0] op_sel_hi:[1,1,1] neg_lo:[1,0,1] neg_hi:[1,0,1]
    v_pk_fma_f32 v[158:159], v[22:23], v[150:151], v[142:143] op_sel:[1,0,0] op_sel_hi:[1,1,1] neg_lo:[1,0,1] neg_hi:[1,0,1]
    v_cvt_pk_bf16_f32 v100, v152, v153
    v_cvt_pk_bf16_f32 v101, v154, v155
    v_cvt_pk_bf16_f32 v102, -v156, -v157
    buffer_load_dwordx4 v[220:223], v11, s[40:43], s73 offen offset:1024 sc1
    v_cvt_pk_bf16_f32 v103, -v158, -v159
    v_pk_fma_f32 v[152:153], v[22:23], v[152:153], v[144:145] op_sel:[1,0,0] op_sel_hi:[1,1,1] neg_lo:[1,0,1] neg_hi:[1,0,1]
    v_pk_fma_f32 v[154:155], v[22:23], v[154:155], v[146:147] op_sel:[1,0,0] op_sel_hi:[1,1,1] neg_lo:[1,0,1] neg_hi:[1,0,1]
    v_pk_fma_f32 v[156:157], v[22:23], v[156:157], v[148:149] op_sel:[1,0,0] op_sel_hi:[1,1,1] neg_lo:[1,0,1] neg_hi:[1,0,1]
    v_pk_fma_f32 v[158:159], v[22:23], v[158:159], v[150:151] op_sel:[1,0,0] op_sel_hi:[1,1,1] neg_lo:[1,0,1] neg_hi:[1,0,1]
    v_cvt_pk_bf16_f32 v116, v152, v153
    v_cvt_pk_bf16_f32 v117, v154, v155
    v_cvt_pk_bf16_f32 v118, -v156, -v157
    v_cvt_pk_bf16_f32 v119, -v158, -v159
    v_mfma_f32_32x32x16_bf16 v[120:135], v[248:251], v[252:255], 0
    s_waitcnt vmcnt(15)
    v_mfma_f32_32x32x16_bf16 v[136:151], a[4:7], v[224:227], 0
    ds_read_b64_tr_b16 a[96:97], v3 offset:24576
    ds_read_b64_tr_b16 a[98:99], v3 offset:25088
    v_mfma_f32_32x32x16_bf16 v[120:135], a[0:3], v[224:227], v[120:135]
    s_add_u32 s68, s65, 8192
    s_cmp_ge_u32 s68, 28672
    s_cselect_b32 s53, 28672, 0
    s_sub_u32 s68, s68, s53
    buffer_load_dwordx4 v[224:227], v10, s[40:43], s68 offen offset:0 sc1
    ds_read_b64_tr_b16 a[100:101], v4 offset:24576
    ds_read_b64_tr_b16 a[102:103], v4 offset:25088
    s_waitcnt vmcnt(15)
    v_mfma_f32_32x32x16_bf16 v[152:167], a[0:3], v[228:231], 0
    ds_read_b64_tr_b16 a[104:105], v3 offset:26624
    ds_read_b64_tr_b16 a[106:107], v3 offset:27136
    v_mfma_f32_32x32x16_bf16 v[168:183], a[4:7], v[228:231], 0
    buffer_load_dwordx4 v[228:231], v11, s[40:43], s68 offen offset:0 sc1
    ds_read_b64_tr_b16 a[108:109], v4 offset:26624
    ds_read_b64_tr_b16 a[110:111], v4 offset:27136
    s_waitcnt vmcnt(15)
    v_mfma_f32_32x32x16_bf16 v[120:135], a[8:11], v[232:235], v[120:135]
    ds_read_b64_tr_b16 a[112:113], v3 offset:28672
    ds_read_b64_tr_b16 a[114:115], v3 offset:29184
    v_mfma_f32_32x32x16_bf16 v[136:151], a[12:15], v[232:235], v[136:151]
    buffer_load_dwordx4 v[232:235], v10, s[40:43], s68 offen offset:1024 sc1
    ds_read_b64_tr_b16 a[116:117], v4 offset:28672
    ds_read_b64_tr_b16 a[118:119], v4 offset:29184
    s_waitcnt vmcnt(15)
    v_mfma_f32_32x32x16_bf16 v[152:167], a[8:11], v[236:239], v[152:167]
    ds_read_b64_tr_b16 a[120:121], v3 offset:30720
    ds_read_b64_tr_b16 a[122:123], v3 offset:31232
    v_mfma_f32_32x32x16_bf16 v[168:183], a[12:15], v[236:239], v[168:183]
    buffer_load_dwordx4 v[236:239], v11, s[40:43], s68 offen offset:1024 sc1
    ds_read_b64_tr_b16 a[124:125], v4 offset:30720
    ds_read_b64_tr_b16 a[126:127], v4 offset:31232
    s_waitcnt vmcnt(15)
    v_mfma_f32_32x32x16_bf16 v[120:135], a[16:19], v[240:243], v[120:135]
    ds_read_b64_tr_b16 a[128:129], v3 offset:0
    ds_read_b64_tr_b16 a[130:131], v3 offset:512
    v_mfma_f32_32x32x16_bf16 v[136:151], a[20:23], v[240:243], v[136:151]
    s_add_u32 s73, s65, 10240
    s_cmp_ge_u32 s73, 28672
    s_cselect_b32 s53, 28672, 0
    s_sub_u32 s73, s73, s53
    buffer_load_dwordx4 v[240:243], v10, s[40:43], s73 offen offset:0 sc1
    ds_read_b64_tr_b16 a[132:133], v4 offset:0
    ds_read_b64_tr_b16 a[134:135], v4 offset:512
    s_waitcnt vmcnt(15)
    v_mfma_f32_32x32x16_bf16 v[152:167], a[16:19], v[244:247], v[152:167]
    ds_read_b64_tr_b16 a[136:137], v3 offset:2048
    ds_read_b64_tr_b16 a[138:139], v3 offset:2560
    v_mfma_f32_32x32x16_bf16 v[168:183], a[20:23], v[244:247], v[168:183]
    buffer_load_dwordx4 v[244:247], v11, s[40:43], s73 offen offset:0 sc1
    ds_read_b64_tr_b16 a[140:141], v4 offset:2048
    ds_read_b64_tr_b16 a[142:143], v4 offset:2560
    s_waitcnt vmcnt(15)
    v_mfma_f32_32x32x16_bf16 v[120:135], a[24:27], v[184:187], v[120:135]
    ds_read_b64_tr_b16 a[144:145], v3 offset:4096
    ds_read_b64_tr_b16 a[146:147], v3 offset:4608
    v_mfma_f32_32x32x16_bf16 v[136:151], a[28:31], v[184:187], v[136:151]
    buffer_load_dwordx4 v[184:187], v10, s[40:43], s73 offen offset:1024 sc1
    ds_read_b64_tr_b16 a[148:149], v4 offset:4096
    ds_read_b64_tr_b16 a[150:151], v4 offset:4608
    s_waitcnt vmcnt(15)
    v_mfma_f32_32x32x16_bf16 v[152:167], a[24:27], v[188:191], v[152:167]
    ds_read_b64_tr_b16 a[152:153], v3 offset:6144
    ds_read_b64_tr_b16 a[154:155], v3 offset:6656
    v_mfma_f32_32x32x16_bf16 v[168:183], a[28:31], v[188:191], v[168:183]
    buffer_load_dwordx4 v[188:191], v11, s[40:43], s73 offen offset:1024 sc1
    ds_read_b64_tr_b16 a[156:157], v4 offset:6144
    ds_read_b64_tr_b16 a[158:159], v4 offset:6656
    s_waitcnt vmcnt(15)
    v_mfma_f32_32x32x16_bf16 v[120:135], a[32:35], v[192:195], v[120:135]
    ds_read_b64_tr_b16 a[160:161], v3 offset:8192
    ds_read_b64_tr_b16 a[162:163], v3 offset:8704
    v_mfma_f32_32x32x16_bf16 v[136:151], a[36:39], v[192:195], v[136:151]
    s_add_u32 s68, s65, 12288
    s_cmp_ge_u32 s68, 28672
    s_cselect_b32 s53, 28672, 0
    s_sub_u32 s68, s68, s53
    buffer_load_dwordx4 v[192:195], v10, s[40:43], s68 offen offset:0 sc1
    ds_read_b64_tr_b16 a[164:165], v4 offset:8192
    ds_read_b64_tr_b16 a[166:167], v4 offset:8704
    s_waitcnt vmcnt(15)
    v_mfma_f32_32x32x16_bf16 v[152:167], a[32:35], v[196:199], v[152:167]
    ds_read_b64_tr_b16 a[168:169], v3 offset:10240
    ds_read_b64_tr_b16 a[170:171], v3 offset:10752
    v_mfma_f32_32x32x16_bf16 v[168:183], a[36:39], v[196:199], v[168:183]
    buffer_load_dwordx4 v[196:199], v11, s[40:43], s68 offen offset:0 sc1
    ds_read_b64_tr_b16 a[172:173], v4 offset:10240
    ds_read_b64_tr_b16 a[174:175], v4 offset:10752
    s_waitcnt vmcnt(15)
    v_mfma_f32_32x32x16_bf16 v[120:135], a[40:43], v[200:203], v[120:135]
    ds_read_b64_tr_b16 a[176:177], v3 offset:12288
    ds_read_b64_tr_b16 a[178:179], v3 offset:12800
    v_mfma_f32_32x32x16_bf16 v[136:151], a[44:47], v[200:203], v[136:151]
    buffer_load_dwordx4 v[200:203], v10, s[40:43], s68 offen offset:1024 sc1
    ds_read_b64_tr_b16 a[180:181], v4 offset:12288
    ds_read_b64_tr_b16 a[182:183], v4 offset:12800
    s_waitcnt vmcnt(15)
    v_mfma_f32_32x32x16_bf16 v[152:167], a[40:43], v[204:207], v[152:167]
    ds_read_b64_tr_b16 a[184:185], v3 offset:14336
    ds_read_b64_tr_b16 a[186:187], v3 offset:14848
    v_mfma_f32_32x32x16_bf16 v[168:183], a[44:47], v[204:207], v[168:183]
    buffer_load_dwordx4 v[204:207], v11, s[40:43], s68 offen offset:1024 sc1
    ds_read_b64_tr_b16 a[188:189], v4 offset:14336
    ds_read_b64_tr_b16 a[190:191], v4 offset:14848
    s_waitcnt vmcnt(15)
    v_mfma_f32_32x32x16_bf16 v[120:135], a[48:51], v[208:211], v[120:135]
    ds_read_b64_tr_b16 a[192:193], v3 offset:16384
    ds_read_b64_tr_b16 a[194:195], v3 offset:16896
    v_mfma_f32_32x32x16_bf16 v[136:151], a[52:55], v[208:211], v[136:151]
    s_add_u32 s73, s65, 14336
    s_cmp_ge_u32 s73, 28672
    s_cselect_b32 s53, 28672, 0
    s_sub_u32 s73, s73, s53
    buffer_load_dwordx4 v[208:211], v10, s[40:43], s73 offen offset:0 sc1
    ds_read_b64_tr_b16 a[196:197], v4 offset:16384
    ds_read_b64_tr_b16 a[198:199], v4 offset:16896
    s_waitcnt vmcnt(15)
    v_mfma_f32_32x32x16_bf16 v[152:167], a[48:51], v[212:215], v[152:167]
    ds_read_b64_tr_b16 a[200:201], v3 offset:18432
    ds_read_b64_tr_b16 a[202:203], v3 offset:18944
    v_mfma_f32_32x32x16_bf16 v[168:183], a[52:55], v[212:215], v[168:183]
    buffer_load_dwordx4 v[212:215], v11, s[40:43], s73 offen offset:0 sc1
    ds_read_b64_tr_b16 a[204:205], v4 offset:18432
    ds_read_b64_tr_b16 a[206:207], v4 offset:18944
    s_waitcnt vmcnt(15)
    v_mfma_f32_32x32x16_bf16 v[120:135], a[56:59], v[216:219], v[120:135]
    ds_read_b64_tr_b16 a[208:209], v3 offset:20480
    ds_read_b64_tr_b16 a[210:211], v3 offset:20992
    v_mfma_f32_32x32x16_bf16 v[136:151], a[60:63], v[216:219], v[136:151]
    buffer_load_dwordx4 v[216:219], v10, s[40:43], s73 offen offset:1024 sc1
    ds_read_b64_tr_b16 a[212:213], v4 offset:20480
    ds_read_b64_tr_b16 a[214:215], v4 offset:20992
    s_waitcnt vmcnt(15)
    v_mfma_f32_32x32x16_bf16 v[152:167], a[56:59], v[220:223], v[152:167]
    ds_read_b64_tr_b16 a[216:217], v3 offset:22528
    ds_read_b64_tr_b16 a[218:219], v3 offset:23040
    v_mfma_f32_32x32x16_bf16 v[168:183], a[60:63], v[220:223], v[168:183]
    buffer_load_dwordx4 v[220:223], v11, s[40:43], s73 offen offset:1024 sc1
    ds_read_b64_tr_b16 a[220:221], v4 offset:22528
    ds_read_b64_tr_b16 a[222:223], v4 offset:23040
    s_waitcnt vmcnt(15)
    v_mfma_f32_32x32x16_bf16 v[120:135], a[64:67], v[224:227], v[120:135]
    v_mfma_f32_32x32x16_bf16 v[136:151], a[68:71], v[224:227], v[136:151]
    s_add_u32 s68, s65, 16384
    s_cmp_ge_u32 s68, 28672
    s_cselect_b32 s53, 28672, 0
    s_sub_u32 s68, s68, s53
    buffer_load_dwordx4 v[224:227], v10, s[40:43], s68 offen offset:0 sc1
    s_waitcnt vmcnt(15)
    v_mfma_f32_32x32x16_bf16 v[152:167], a[64:67], v[228:231], v[152:167]
    v_mfma_f32_32x32x16_bf16 v[168:183], a[68:71], v[228:231], v[168:183]
    buffer_load_dwordx4 v[228:231], v11, s[40:43], s68 offen offset:0 sc1
    s_waitcnt vmcnt(15)
    v_mfma_f32_32x32x16_bf16 v[120:135], a[72:75], v[232:235], v[120:135]
    v_mfma_f32_32x32x16_bf16 v[136:151], a[76:79], v[232:235], v[136:151]
    buffer_load_dwordx4 v[232:235], v10, s[40:43], s68 offen offset:1024 sc1
    s_waitcnt lgkmcnt(0)
    v_lshrrev_b32 v14, 2, v0
    v_and_b32 v48, 3, v0
    v_lshlrev_b32 v14, 16, v14
    v_lshl_add_u32 v14, v48, 4, v14
    v_add_u32 v48, 1047552, v14
    s_add_u32 m0, s66, 12288
    s_nop 0
    buffer_load_dwordx4 v14, s[4:7], s71 offen lds
    buffer_load_dwordx4 v48, s[4:7], s71 offen offset:1024 lds
    s_waitcnt vmcnt(17)
    v_mfma_f32_32x32x16_bf16 v[152:167], a[72:75], v[236:239], v[152:167]
    v_mfma_f32_32x32x16_bf16 v[168:183], a[76:79], v[236:239], v[168:183]
    buffer_load_dwordx4 v[236:239], v11, s[40:43], s68 offen offset:1024 sc1
    v_and_b32 v36, 3, v0
    v_bfe_u32 v37, v0, 3, 2
    s_waitcnt vmcnt(17)
    v_mfma_f32_32x32x16_bf16 v[120:135], a[80:83], v[240:243], v[120:135]
    v_lshl_add_u32 v36, v37, 2, v36
    v_lshlrev_b32 v36, 4, v36
    v_mfma_f32_32x32x16_bf16 v[136:151], a[84:87], v[240:243], v[136:151]
    s_add_u32 s73, s65, 18432
    s_cmp_ge_u32 s73, 28672
    s_cselect_b32 s53, 28672, 0
    s_sub_u32 s73, s73, s53
    buffer_load_dwordx4 v[240:243], v10, s[40:43], s73 offen offset:0 sc1
    v_bfe_u32 v37, v0, 2, 1
    v_lshl_add_u32 v36, v37, 10, v36
    s_waitcnt vmcnt(17)
    v_mfma_f32_32x32x16_bf16 v[152:167], a[80:83], v[244:247], v[152:167]
    v_lshrrev_b32 v37, 5, v0
    v_lshl_add_u32 v36, v37, 8, v36
    v_mfma_f32_32x32x16_bf16 v[168:183], a[84:87], v[244:247], v[168:183]
    buffer_load_dwordx4 v[244:247], v11, s[40:43], s73 offen offset:0 sc1
    s_lshl_b32 s54, s44, 11
    s_add_u32 s54, s54, 16384
    s_waitcnt vmcnt(17)
    v_mfma_f32_32x32x16_bf16 v[120:135], a[88:91], v[184:187], v[120:135]
    v_add_u32 v16, s54, v36
    v_add_u32 v3, 67584, v16
    v_mfma_f32_32x32x16_bf16 v[136:151], a[92:95], v[184:187], v[136:151]
    buffer_load_dwordx4 v[184:187], v10, s[40:43], s73 offen offset:1024 sc1
    v_and_b32 v54, 31, v0
    v_and_b32 v36, 32, v0
    s_waitcnt vmcnt(17)
    v_mfma_f32_32x32x16_bf16 v[152:167], a[88:91], v[188:191], v[152:167]
    v_lshl_add_u32 v54, v54, 6, v36
    v_add_u32 v54, s66, v54
    v_mfma_f32_32x32x16_bf16 v[168:183], a[92:95], v[188:191], v[168:183]
    buffer_load_dwordx4 v[188:191], v11, s[40:43], s73 offen offset:1024 sc1
    v_lshlrev_b32 v36, 4, v0
    v_add_u32 v15, s66, v36
    s_waitcnt vmcnt(17)
    v_mfma_f32_32x32x16_bf16 v[120:135], a[96:99], v[192:195], v[120:135]
    s_xor_b32 s54, s44, 1
    s_mul_i32 s54, s54, 33792
    v_mfma_f32_32x32x16_bf16 v[136:151], a[100:103], v[192:195], v[136:151]
    s_add_u32 s68, s65, 20480
    s_cmp_ge_u32 s68, 28672
    s_cselect_b32 s53, 28672, 0
    s_sub_u32 s68, s68, s53
    buffer_load_dwordx4 v[192:195], v10, s[40:43], s68 offen offset:0 sc1
    s_add_u32 s54, s54, 0
    v_add_u32 v17, s54, v36
    s_waitcnt vmcnt(17)
    v_mfma_f32_32x32x16_bf16 v[152:167], a[96:99], v[196:199], v[152:167]
    s_xor_b32 s54, s44, 2
    s_mul_i32 s54, s54, 33792
    v_mfma_f32_32x32x16_bf16 v[168:183], a[100:103], v[196:199], v[168:183]
    buffer_load_dwordx4 v[196:199], v11, s[40:43], s68 offen offset:0 sc1
    s_add_u32 s54, s54, 4096
    v_add_u32 v18, s54, v36
    s_waitcnt vmcnt(17)
    v_mfma_f32_32x32x16_bf16 v[120:135], a[104:107], v[200:203], v[120:135]
    s_xor_b32 s54, s44, 3
    s_mul_i32 s54, s54, 33792
    v_mfma_f32_32x32x16_bf16 v[136:151], a[108:111], v[200:203], v[136:151]
    buffer_load_dwordx4 v[200:203], v10, s[40:43], s68 offen offset:1024 sc1
    s_lshr_b32 s60, s49, 3
    s_lshl2_add_u32 s60, s60, s44
    s_lshl_b32 s60, s60, 8
    s_add_u32 s60, s60, 12591104
    v_lshlrev_b32 v6, 2, v0
    buffer_load_dword v7, v6, s[40:43], s60 offen sc1
    s_add_u32 s54, s54, 8192
    v_add_u32 v19, s54, v36
    s_waitcnt vmcnt(18)
    v_mfma_f32_32x32x16_bf16 v[152:167], a[104:107], v[204:207], v[152:167]
    v_mfma_f32_32x32x16_bf16 v[168:183], a[108:111], v[204:207], v[168:183]
    buffer_load_dwordx4 v[204:207], v11, s[40:43], s68 offen offset:1024 sc1
    s_waitcnt vmcnt(18)
    v_mfma_f32_32x32x16_bf16 v[120:135], a[112:115], v[208:211], v[120:135]
    v_mfma_f32_32x32x16_bf16 v[136:151], a[116:119], v[208:211], v[136:151]
    s_add_u32 s73, s65, 22528
    s_cmp_ge_u32 s73, 28672
    s_cselect_b32 s53, 28672, 0
    s_sub_u32 s73, s73, s53
    buffer_load_dwordx4 v[208:211], v10, s[40:43], s73 offen offset:0 sc1
    s_waitcnt vmcnt(18)
    v_mfma_f32_32x32x16_bf16 v[152:167], a[112:115], v[212:215], v[152:167]
    v_mfma_f32_32x32x16_bf16 v[168:183], a[116:119], v[212:215], v[168:183]
    buffer_load_dwordx4 v[212:215], v11, s[40:43], s73 offen offset:0 sc1
    s_waitcnt vmcnt(18)
    v_mfma_f32_32x32x16_bf16 v[120:135], a[120:123], v[216:219], v[120:135]
    v_mfma_f32_32x32x16_bf16 v[136:151], a[124:127], v[216:219], v[136:151]
    buffer_load_dwordx4 v[216:219], v10, s[40:43], s73 offen offset:1024 sc1
    s_waitcnt vmcnt(18)
    v_mfma_f32_32x32x16_bf16 v[152:167], a[120:123], v[220:223], v[152:167]
    v_mfma_f32_32x32x16_bf16 v[168:183], a[124:127], v[220:223], v[168:183]
    buffer_load_dwordx4 v[220:223], v11, s[40:43], s73 offen offset:1024 sc1
    s_waitcnt vmcnt(18)
    v_mfma_f32_32x32x16_bf16 v[120:135], a[128:131], v[224:227], v[120:135]
    v_mfma_f32_32x32x16_bf16 v[136:151], a[132:135], v[224:227], v[136:151]
    s_add_u32 s68, s65, 24576
    s_cmp_ge_u32 s68, 28672
    s_cselect_b32 s53, 28672, 0
    s_sub_u32 s68, s68, s53
    buffer_load_dwordx4 v[224:227], v11, s[40:43], s68 offen offset:0 sc1
    s_waitcnt vmcnt(18)
    v_mfma_f32_32x32x16_bf16 v[152:167], a[128:131], v[228:231], v[152:167]
    v_mfma_f32_32x32x16_bf16 v[168:183], a[132:135], v[228:231], v[168:183]
    buffer_load_dwordx4 v[228:231], v11, s[40:43], s68 offen offset:1024 sc1
    s_waitcnt vmcnt(18)
    v_mfma_f32_32x32x16_bf16 v[120:135], a[136:139], v[232:235], v[120:135]
    v_mfma_f32_32x32x16_bf16 v[136:151], a[140:143], v[232:235], v[136:151]
    s_add_u32 s73, s65, 26624
    s_cmp_ge_u32 s73, 28672
    s_cselect_b32 s53, 28672, 0
    s_sub_u32 s73, s73, s53
    buffer_load_dwordx4 v[232:235], v11, s[40:43], s73 offen offset:0 sc1
    s_waitcnt vmcnt(16)
    v_mfma_f32_32x32x16_bf16 v[152:167], a[136:139], v[236:239], v[152:167]
    v_mfma_f32_32x32x16_bf16 v[168:183], a[140:143], v[236:239], v[168:183]
    buffer_load_dwordx4 v[236:239], v11, s[40:43], s73 offen offset:1024 sc1
    s_waitcnt vmcnt(16)
    v_mfma_f32_32x32x16_bf16 v[120:135], a[144:147], v[240:243], v[120:135]
    v_mfma_f32_32x32x16_bf16 v[136:151], a[148:151], v[240:243], v[136:151]
    buffer_load_dwordx4 v[240:243], v10, s[40:43], s68 offen offset:0 sc1
    ds_read_b128 v[36:39], v54 offset:12288
    ds_read_b128 v[248:251], v54 offset:12304
    s_waitcnt vmcnt(16)
    v_mfma_f32_32x32x16_bf16 v[152:167], a[144:147], v[244:247], v[152:167]
    v_mfma_f32_32x32x16_bf16 v[168:183], a[148:151], v[244:247], v[168:183]
    buffer_load_dwordx4 v[244:247], v10, s[40:43], s68 offen offset:1024 sc1
    s_waitcnt vmcnt(16)
    v_mfma_f32_32x32x16_bf16 v[120:135], a[152:155], v[184:187], v[120:135]
    v_mfma_f32_32x32x16_bf16 v[136:151], a[156:159], v[184:187], v[136:151]
    buffer_load_dwordx4 v[184:187], v10, s[40:43], s73 offen offset:0 sc1
    s_waitcnt lgkmcnt(1)
    v_lshlrev_b32 v20, 16, v36
    v_and_b32 v21, 0xffff0000, v36
    s_waitcnt vmcnt(16)
    v_mfma_f32_32x32x16_bf16 v[152:167], a[152:155], v[188:191], v[152:167]
    v_lshlrev_b32 v22, 16, v37
    v_and_b32 v23, 0xffff0000, v37
    v_mfma_f32_32x32x16_bf16 v[168:183], a[156:159], v[188:191], v[168:183]
    buffer_load_dwordx4 v[188:191], v10, s[40:43], s73 offen offset:1024 sc1
    v_lshlrev_b32 v24, 16, v38
    v_and_b32 v25, 0xffff0000, v38
    s_waitcnt vmcnt(16)
    v_mfma_f32_32x32x16_bf16 v[120:135], a[160:163], v[192:195], v[120:135]
    s_waitcnt vmcnt(13)
    v_cmp_ne_u32 vcc, 1, v7
    s_cbranch_vccnz SPIN_y
BACK_y:
    s_lshl_b32 s52, s49, 16
    s_lshl_b32 s53, s44, 13
    s_add_u32 s52, s52, s53
    s_add_u32 s69, s52, 10485760
    v_sub_u32 v12, 0, v2
    v_and_b32 v12, 3, v12
    v_xor_b32 v12, v12, v0
    v_lshlrev_b32 v12, 4, v12
    s_add_u32 m0, s66, 16384
    s_add_u32 s70, s69, 0
    buffer_load_dwordx4 v12, s[40:43], s70 offen offset:0 sc1 lds
    v_lshlrev_b32 v26, 16, v39
    v_and_b32 v27, 0xffff0000, v39
    v_mfma_f32_32x32x16_bf16 v[136:151], a[164:167], v[192:195], v[136:151]
    buffer_load_dwordx4 v12, s[40:43], s70 offen offset:1024 sc1 lds
    s_waitcnt lgkmcnt(0)
    v_lshlrev_b32 v28, 16, v248
    v_and_b32 v29, 0xffff0000, v248
    v_mfma_f32_32x32x16_bf16 v[152:167], a[160:163], v[196:199], v[152:167]
    buffer_load_dwordx4 v12, s[40:43], s70 offen offset:2048 sc1 lds
    v_lshlrev_b32 v30, 16, v249
    v_and_b32 v31, 0xffff0000, v249
    v_mfma_f32_32x32x16_bf16 v[168:183], a[164:167], v[196:199], v[168:183]
    buffer_load_dwordx4 v12, s[40:43], s70 offen offset:3072 sc1 lds
    v_lshlrev_b32 v32, 16, v250
    v_and_b32 v33, 0xffff0000, v250
    v_mfma_f32_32x32x16_bf16 v[120:135], a[168:171], v[200:203], v[120:135]
    s_add_u32 m0, s66, 20480
    s_add_u32 s70, s69, 4096
    buffer_load_dwordx4 v12, s[40:43], s70 offen offset:0 sc1 lds
    v_lshlrev_b32 v34, 16, v251
    v_and_b32 v35, 0xffff0000, v251
    v_mfma_f32_32x32x16_bf16 v[136:151], a[172:175], v[200:203], v[136:151]
    buffer_load_dwordx4 v12, s[40:43], s70 offen offset:1024 sc1 lds
    s_waitcnt vmcnt(18)
    v_mfma_f32_32x32x16_bf16 v[152:167], a[168:171], v[204:207], v[152:167]
    buffer_load_dwordx4 v12, s[40:43], s70 offen offset:2048 sc1 lds
    v_mfma_f32_32x32x16_bf16 v[168:183], a[172:175], v[204:207], v[168:183]
    buffer_load_dwordx4 v12, s[40:43], s70 offen offset:3072 sc1 lds
    s_waitcnt vmcnt(19)
    v_mfma_f32_32x32x16_bf16 v[120:135], a[176:179], v[208:211], v[120:135]
    s_add_u32 m0, s66, 24576
    s_add_u32 s70, s69, 32768
    buffer_load_dwordx4 v12, s[40:43], s70 offen offset:0 sc1 lds
    v_mfma_f32_32x32x16_bf16 v[136:151], a[180:183], v[208:211], v[136:151]
    buffer_load_dwordx4 v12, s[40:43], s70 offen offset:1024 sc1 lds
    s_waitcnt vmcnt(20)
    v_mfma_f32_32x32x16_bf16 v[152:167], a[176:179], v[212:215], v[152:167]
    buffer_load_dwordx4 v12, s[40:43], s70 offen offset:2048 sc1 lds
    v_mfma_f32_32x32x16_bf16 v[168:183], a[180:183], v[212:215], v[168:183]
    buffer_load_dwordx4 v12, s[40:43], s70 offen offset:3072 sc1 lds
    s_waitcnt vmcnt(21)
    v_mfma_f32_32x32x16_bf16 v[120:135], a[184:187], v[216:219], v[120:135]
    s_add_u32 m0, s66, 28672
    s_add_u32 s70, s69, 36864
    buffer_load_dwordx4 v12, s[40:43], s70 offen offset:0 sc1 lds
    v_mfma_f32_32x32x16_bf16 v[136:151], a[188:191], v[216:219], v[136:151]
    buffer_load_dwordx4 v12, s[40:43], s70 offen offset:1024 sc1 lds
    s_waitcnt vmcnt(22)
    v_mfma_f32_32x32x16_bf16 v[152:167], a[184:187], v[220:223], v[152:167]
    buffer_load_dwordx4 v12, s[40:43], s70 offen offset:2048 sc1 lds
    v_mfma_f32_32x32x16_bf16 v[168:183], a[188:191], v[220:223], v[168:183]
    buffer_load_dwordx4 v12, s[40:43], s70 offen offset:3072 sc1 lds
    s_waitcnt vmcnt(23)
    v_mfma_f32_32x32x16_bf16 v[152:167], a[192:195], v[224:227], v[152:167]
    v_mfma_f32_32x32x16_bf16 v[168:183], a[196:199], v[224:227], v[168:183]
    s_waitcnt vmcnt(22)
    v_mfma_f32_32x32x16_bf16 v[152:167], a[200:203], v[228:231], v[152:167]
    v_mfma_f32_32x32x16_bf16 v[168:183], a[204:207], v[228:231], v[168:183]
    s_waitcnt vmcnt(21)
    v_mfma_f32_32x32x16_bf16 v[152:167], a[208:211], v[232:235], v[152:167]
    v_mfma_f32_32x32x16_bf16 v[168:183], a[212:215], v[232:235], v[168:183]
    s_waitcnt vmcnt(20)
    v_mfma_f32_32x32x16_bf16 v[152:167], a[216:219], v[236:239], v[152:167]
    v_mfma_f32_32x32x16_bf16 v[168:183], a[220:223], v[236:239], v[168:183]
    s_waitcnt vmcnt(19)
    v_mfma_f32_32x32x16_bf16 v[120:135], a[192:195], v[240:243], v[120:135]
    v_mfma_f32_32x32x16_bf16 v[136:151], a[196:199], v[240:243], v[136:151]
    s_nop 7
    ds_write_b128 v15, v[152:155] offset:4096
    ds_write_b128 v15, v[156:159] offset:5120
    s_waitcnt vmcnt(18)
    v_mfma_f32_32x32x16_bf16 v[120:135], a[200:203], v[244:247], v[120:135]
    ds_write_b128 v15, v[160:163] offset:6144
    ds_write_b128 v15, v[164:167] offset:7168
    v_mfma_f32_32x32x16_bf16 v[136:151], a[204:207], v[244:247], v[136:151]
    ds_write_b128 v15, v[168:171] offset:8192
    ds_write_b128 v15, v[172:175] offset:9216
    s_waitcnt vmcnt(17)
    v_mfma_f32_32x32x16_bf16 v[120:135], a[208:211], v[184:187], v[120:135]
    ds_write_b128 v15, v[176:179] offset:10240
    ds_write_b128 v15, v[180:183] offset:11264
    v_mfma_f32_32x32x16_bf16 v[136:151], a[212:215], v[184:187], v[136:151]
    s_waitcnt vmcnt(16)
    v_mfma_f32_32x32x16_bf16 v[120:135], a[216:219], v[188:191], v[120:135]
    v_mfma_f32_32x32x16_bf16 v[136:151], a[220:223], v[188:191], v[136:151]
    v_lshrrev_b32 v12, 2, v1
    v_sub_u32 v12, 0, v12
    v_xor_b32 v12, v12, v2
    v_and_b32 v12, 3, v12
    v_lshlrev_b32 v12, 4, v12
    v_lshl_add_u32 v12, v1, 6, v12
    v_add_u32 v12, s66, v12
    s_waitcnt vmcnt(12)
    ds_read_b128 a[0:3], v12 offset:16384
    ds_read_b128 a[4:7], v12 offset:17408
    ds_read_b128 a[8:11], v12 offset:18432
    ds_read_b128 a[12:15], v12 offset:19456
    s_waitcnt lgkmcnt(3)
    v_mfma_f32_16x16x32_bf16 v[184:187], a[0:3], v[56:59], 0
    ds_write_b128 v15, v[136:139] offset:0
    v_mfma_f32_16x16x32_bf16 v[192:195], a[0:3], v[60:63], 0
    ds_write_b128 v15, v[140:143] offset:1024
    v_mfma_f32_16x16x32_bf16 v[200:203], a[0:3], v[64:67], 0
    ds_write_b128 v15, v[144:147] offset:2048
    v_mfma_f32_16x16x32_bf16 v[208:211], a[0:3], v[68:71], 0
    ds_write_b128 v15, v[148:151] offset:3072
    s_waitcnt lgkmcnt(6)
    v_mfma_f32_16x16x32_bf16 v[188:191], a[4:7], v[56:59], 0
    s_waitcnt vmcnt(8)
    ds_read_b128 a[16:19], v12 offset:20480
    v_mfma_f32_16x16x32_bf16 v[196:199], a[4:7], v[60:63], 0
    ds_read_b128 a[20:23], v12 offset:21504
    v_mfma_f32_16x16x32_bf16 v[204:207], a[4:7], v[64:67], 0
    ds_read_b128 a[24:27], v12 offset:22528
    v_mfma_f32_16x16x32_bf16 v[212:215], a[4:7], v[68:71], 0
    ds_read_b128 a[28:31], v12 offset:23552
    s_waitcnt lgkmcnt(9)
    v_mfma_f32_16x16x32_bf16 v[184:187], a[8:11], v[72:75], v[184:187]
    s_waitcnt vmcnt(4)
    ds_read_b128 a[32:35], v12 offset:24576
    v_mfma_f32_16x16x32_bf16 v[192:195], a[8:11], v[76:79], v[192:195]
    ds_read_b128 a[36:39], v12 offset:25600
    v_mfma_f32_16x16x32_bf16 v[200:203], a[8:11], v[80:83], v[200:203]
    ds_read_b128 a[40:43], v12 offset:26624
    v_mfma_f32_16x16x32_bf16 v[208:211], a[8:11], v[84:87], v[208:211]
    ds_read_b128 a[44:47], v12 offset:27648
    s_waitcnt lgkmcnt(12)
    v_mfma_f32_16x16x32_bf16 v[188:191], a[12:15], v[72:75], v[188:191]
    s_waitcnt vmcnt(0)
    ds_read_b128 a[48:51], v12 offset:28672
    v_mfma_f32_16x16x32_bf16 v[196:199], a[12:15], v[76:79], v[196:199]
    ds_read_b128 a[52:55], v12 offset:29696
    v_mfma_f32_16x16x32_bf16 v[204:207], a[12:15], v[80:83], v[204:207]
    ds_read_b128 a[56:59], v12 offset:30720
    v_mfma_f32_16x16x32_bf16 v[212:215], a[12:15], v[84:87], v[212:215]
    ds_read_b128 a[60:63], v12 offset:31744
    s_waitcnt lgkmcnt(0)
    s_barrier
    v_mfma_f32_16x16x32_bf16 v[184:187], a[16:19], v[88:91], v[184:187]
    ds_read_b128 v[136:139], v17 offset:0
    ds_read_b128 v[152:155], v18 offset:0
    v_mfma_f32_16x16x32_bf16 v[192:195], a[16:19], v[92:95], v[192:195]
    ds_read_b128 v[168:171], v19 offset:0
    ds_read_b128 v[140:143], v17 offset:1024
    v_mfma_f32_16x16x32_bf16 v[200:203], a[16:19], v[96:99], v[200:203]
    ds_read_b128 v[156:159], v18 offset:1024
    ds_read_b128 v[172:175], v19 offset:1024
    v_mfma_f32_16x16x32_bf16 v[208:211], a[16:19], v[100:103], v[208:211]
    ds_read_b128 v[144:147], v17 offset:2048
    ds_read_b128 v[160:163], v18 offset:2048
    v_mfma_f32_16x16x32_bf16 v[188:191], a[20:23], v[88:91], v[188:191]
    ds_read_b128 v[176:179], v19 offset:2048
    ds_read_b128 v[148:151], v17 offset:3072
    v_mfma_f32_16x16x32_bf16 v[196:199], a[20:23], v[92:95], v[196:199]
    ds_read_b128 v[164:167], v18 offset:3072
    ds_read_b128 v[180:183], v19 offset:3072
    v_mfma_f32_16x16x32_bf16 v[204:207], a[20:23], v[96:99], v[204:207]
    s_mov_b32 s74, 0xbfb8aa3b
    s_waitcnt lgkmcnt(10)
    v_add_f32 v136, v136, v152
    v_mfma_f32_16x16x32_bf16 v[212:215], a[20:23], v[100:103], v[212:215]
    s_waitcnt lgkmcnt(9)
    v_add_f32 v120, v120, v168
    v_add_f32 v137, v137, v153
    v_mfma_f32_16x16x32_bf16 v[184:187], a[24:27], v[104:107], v[184:187]
    v_add_f32 v121, v121, v169
    v_add_f32 v138, v138, v154
    v_mfma_f32_16x16x32_bf16 v[192:195], a[24:27], v[108:111], v[192:195]
    v_add_f32 v122, v122, v170
    v_add_f32 v139, v139, v155
    v_mfma_f32_16x16x32_bf16 v[200:203], a[24:27], v[112:115], v[200:203]
    v_add_f32 v123, v123, v171
    v_add_f32 v120, v120, v136
    v_mfma_f32_16x16x32_bf16 v[208:211], a[24:27], v[116:119], v[208:211]
    v_add_f32 v121, v121, v137
    v_add_f32 v122, v122, v138
    v_mfma_f32_16x16x32_bf16 v[188:191], a[28:31], v[104:107], v[188:191]
    v_add_f32 v123, v123, v139
    v_mul_f32 v36, s74, v120
    v_mfma_f32_16x16x32_bf16 v[196:199], a[28:31], v[108:111], v[196:199]
    v_mul_f32 v37, s74, v121
    v_mul_f32 v38, s74, v122
    v_mfma_f32_16x16x32_bf16 v[204:207], a[28:31], v[112:115], v[204:207]
    v_mul_f32 v39, s74, v123
    v_exp_f32 v36, v36
    v_mfma_f32_16x16x32_bf16 v[212:215], a[28:31], v[116:119], v[212:215]
    v_exp_f32 v37, v37
    v_exp_f32 v38, v38
    v_mfma_f32_16x16x32_bf16 v[216:219], a[32:35], v[56:59], 0
    v_exp_f32 v39, v39
    v_add_f32 v36, 1.0, v36
    v_mfma_f32_16x16x32_bf16 v[224:227], a[32:35], v[60:63], 0
    v_add_f32 v37, 1.0, v37
    v_add_f32 v38, 1.0, v38
    v_mfma_f32_16x16x32_bf16 v[232:235], a[32:35], v[64:67], 0
    v_add_f32 v39, 1.0, v39
    v_rcp_f32 v36, v36
    v_mfma_f32_16x16x32_bf16 v[240:243], a[32:35], v[68:71], 0
    v_rcp_f32 v37, v37
    v_rcp_f32 v38, v38
    v_mfma_f32_16x16x32_bf16 v[220:223], a[36:39], v[56:59], 0
    v_rcp_f32 v39, v39
    v_mul_f32 v120, v120, v36
    v_mfma_f32_16x16x32_bf16 v[228:231], a[36:39], v[60:63], 0
    v_mul_f32 v121, v121, v37
    v_mul_f32 v122, v122, v38
    v_mfma_f32_16x16x32_bf16 v[236:239], a[36:39], v[64:67], 0
    v_mul_f32 v123, v123, v39
    s_waitcnt lgkmcnt(7)
    v_add_f32 v140, v140, v156
    v_mfma_f32_16x16x32_bf16 v[244:247], a[36:39], v[68:71], 0
    s_waitcnt lgkmcnt(6)
    v_add_f32 v124, v124, v172
    v_add_f32 v141, v141, v157
    v_mfma_f32_16x16x32_bf16 v[216:219], a[40:43], v[72:75], v[216:219]
    v_add_f32 v125, v125, v173
    v_add_f32 v142, v142, v158
    v_mfma_f32_16x16x32_bf16 v[224:227], a[40:43], v[76:79], v[224:227]
    v_add_f32 v126, v126, v174
    v_add_f32 v143, v143, v159
    v_mfma_f32_16x16x32_bf16 v[232:235], a[40:43], v[80:83], v[232:235]
    v_add_f32 v127, v127, v175
    v_add_f32 v124, v124, v140
    v_mfma_f32_16x16x32_bf16 v[240:243], a[40:43], v[84:87], v[240:243]
    v_add_f32 v125, v125, v141
    v_add_f32 v126, v126, v142
    v_mfma_f32_16x16x32_bf16 v[220:223], a[44:47], v[72:75], v[220:223]
    v_add_f32 v127, v127, v143
    v_mul_f32 v36, s74, v124
    v_mfma_f32_16x16x32_bf16 v[228:231], a[44:47], v[76:79], v[228:231]
    v_mul_f32 v37, s74, v125
    v_mul_f32 v38, s74, v126
    v_mfma_f32_16x16x32_bf16 v[236:239], a[44:47], v[80:83], v[236:239]
    v_mul_f32 v39, s74, v127
    v_exp_f32 v36, v36
    v_mfma_f32_16x16x32_bf16 v[244:247], a[44:47], v[84:87], v[244:247]
    v_exp_f32 v37, v37
    v_exp_f32 v38, v38
    v_mfma_f32_16x16x32_bf16 v[216:219], a[48:51], v[88:91], v[216:219]
    v_exp_f32 v39, v39
    v_add_f32 v36, 1.0, v36
    v_mfma_f32_16x16x32_bf16 v[224:227], a[48:51], v[92:95], v[224:227]
    v_add_f32 v37, 1.0, v37
    v_add_f32 v38, 1.0, v38
    v_mfma_f32_16x16x32_bf16 v[232:235], a[48:51], v[96:99], v[232:235]
    v_cvt_pk_bf16_f32 v184, v184, v185
    v_cvt_pk_bf16_f32 v185, v186, v187
    v_mfma_f32_16x16x32_bf16 v[240:243], a[48:51], v[100:103], v[240:243]
    v_cvt_pk_bf16_f32 v186, v188, v189
    v_cvt_pk_bf16_f32 v187, v190, v191
    v_mfma_f32_16x16x32_bf16 v[220:223], a[52:55], v[88:91], v[220:223]
    ds_write_b128 v15, v[184:187] offset:16384
    v_cvt_pk_bf16_f32 v192, v192, v193
    v_mfma_f32_16x16x32_bf16 v[228:231], a[52:55], v[92:95], v[228:231]
    v_cvt_pk_bf16_f32 v193, v194, v195
    v_cvt_pk_bf16_f32 v194, v196, v197
    v_mfma_f32_16x16x32_bf16 v[236:239], a[52:55], v[96:99], v[236:239]
    v_cvt_pk_bf16_f32 v195, v198, v199
    ds_write_b128 v15, v[192:195] offset:17408
    v_mfma_f32_16x16x32_bf16 v[244:247], a[52:55], v[100:103], v[244:247]
    v_cvt_pk_bf16_f32 v200, v200, v201
    v_cvt_pk_bf16_f32 v201, v202, v203
    v_mfma_f32_16x16x32_bf16 v[216:219], a[56:59], v[104:107], v[216:219]
    v_cvt_pk_bf16_f32 v202, v204, v205
    v_cvt_pk_bf16_f32 v203, v206, v207
    v_mfma_f32_16x16x32_bf16 v[224:227], a[56:59], v[108:111], v[224:227]
    ds_write_b128 v15, v[200:203] offset:18432
    v_cvt_pk_bf16_f32 v208, v208, v209
    v_mfma_f32_16x16x32_bf16 v[232:235], a[56:59], v[112:115], v[232:235]
    v_cvt_pk_bf16_f32 v209, v210, v211
    v_cvt_pk_bf16_f32 v210, v212, v213
    v_mfma_f32_16x16x32_bf16 v[240:243], a[56:59], v[116:119], v[240:243]
    v_cvt_pk_bf16_f32 v211, v214, v215
    ds_write_b128 v15, v[208:211] offset:19456
    v_mfma_f32_16x16x32_bf16 v[220:223], a[60:63], v[104:107], v[220:223]
    v_add_f32 v39, 1.0, v39
    v_rcp_f32 v36, v36
    v_mfma_f32_16x16x32_bf16 v[228:231], a[60:63], v[108:111], v[228:231]
    v_rcp_f32 v37, v37
    v_rcp_f32 v38, v38
    v_mfma_f32_16x16x32_bf16 v[236:239], a[60:63], v[112:115], v[236:239]
    v_rcp_f32 v39, v39
    v_mul_f32 v124, v124, v36
    v_mfma_f32_16x16x32_bf16 v[244:247], a[60:63], v[116:119], v[244:247]
    v_mul_f32 v125, v125, v37
    v_mul_f32 v126, v126, v38
    v_cvt_pk_bf16_f32 v216, v216, v217
    v_cvt_pk_bf16_f32 v217, v218, v219
    v_cvt_pk_bf16_f32 v218, v220, v221
    v_cvt_pk_bf16_f32 v219, v222, v223
    ds_write_b128 v15, v[216:219] offset:20480
    v_cvt_pk_bf16_f32 v224, v224, v225
    v_cvt_pk_bf16_f32 v225, v226, v227
    v_cvt_pk_bf16_f32 v226, v228, v229
    v_cvt_pk_bf16_f32 v227, v230, v231
    ds_write_b128 v15, v[224:227] offset:21504
    v_cvt_pk_bf16_f32 v232, v232, v233
    v_cvt_pk_bf16_f32 v233, v234, v235
    v_cvt_pk_bf16_f32 v234, v236, v237
    v_cvt_pk_bf16_f32 v235, v238, v239
    ds_write_b128 v15, v[232:235] offset:22528
    v_cvt_pk_bf16_f32 v240, v240, v241
    v_cvt_pk_bf16_f32 v241, v242, v243
    v_cvt_pk_bf16_f32 v242, v244, v245
    v_cvt_pk_bf16_f32 v243, v246, v247
    ds_write_b128 v15, v[240:243] offset:23552
    v_mul_f32 v127, v127, v39
    s_waitcnt lgkmcnt(12)
    v_add_f32 v144, v144, v160
    s_waitcnt lgkmcnt(11)
    v_add_f32 v128, v128, v176
    v_add_f32 v145, v145, v161
    v_add_f32 v129, v129, v177
    v_add_f32 v146, v146, v162
    v_add_f32 v130, v130, v178
    v_add_f32 v147, v147, v163
    v_add_f32 v131, v131, v179
    v_add_f32 v128, v128, v144
    v_add_f32 v129, v129, v145
    v_add_f32 v130, v130, v146
    v_add_f32 v131, v131, v147
    v_mul_f32 v36, s74, v128
    v_mul_f32 v37, s74, v129
    v_mul_f32 v38, s74, v130
    v_mul_f32 v39, s74, v131
    v_exp_f32 v36, v36
    v_exp_f32 v37, v37
    v_exp_f32 v38, v38
    v_exp_f32 v39, v39
    v_add_f32 v36, 1.0, v36
    v_add_f32 v37, 1.0, v37
    v_add_f32 v38, 1.0, v38
    v_add_f32 v39, 1.0, v39
    v_rcp_f32 v36, v36
    v_rcp_f32 v37, v37
    v_rcp_f32 v38, v38
    v_rcp_f32 v39, v39
    v_mul_f32 v128, v128, v36
    v_mul_f32 v129, v129, v37
    v_mul_f32 v130, v130, v38
    v_mul_f32 v131, v131, v39
    s_waitcnt lgkmcnt(9)
    v_add_f32 v148, v148, v164
    s_waitcnt lgkmcnt(8)
    v_add_f32 v132, v132, v180
    v_add_f32 v149, v149, v165
    v_add_f32 v133, v133, v181
    v_add_f32 v150, v150, v166
    v_add_f32 v134, v134, v182
    v_add_f32 v151, v151, v167
    v_add_f32 v135, v135, v183
    v_add_f32 v132, v132, v148
    v_add_f32 v133, v133, v149
    v_add_f32 v134, v134, v150
    v_add_f32 v135, v135, v151
    v_mul_f32 v36, s74, v132
    v_mul_f32 v37, s74, v133
    v_mul_f32 v38, s74, v134
    v_mul_f32 v39, s74, v135
    v_exp_f32 v36, v36
    v_exp_f32 v37, v37
    v_exp_f32 v38, v38
    v_exp_f32 v39, v39
    v_add_f32 v36, 1.0, v36
    v_add_f32 v37, 1.0, v37
    v_add_f32 v38, 1.0, v38
    v_add_f32 v39, 1.0, v39
    v_rcp_f32 v36, v36
    v_rcp_f32 v37, v37
    v_rcp_f32 v38, v38
    v_rcp_f32 v39, v39
    v_mul_f32 v132, v132, v36
    v_mul_f32 v133, v133, v37
    v_mul_f32 v134, v134, v38
    v_mul_f32 v135, v135, v39
    s_waitcnt lgkmcnt(0)
    s_barrier
    ds_read_b128 a[0:3], v16 offset:0
    ds_read_b128 a[4:7], v16 offset:512
    ds_read_b128 a[8:11], v16 offset:33792
    ds_read_b128 a[12:15], v16 offset:34304
    ds_read_b128 a[16:19], v3 offset:0
    ds_read_b128 a[20:23], v3 offset:512
    ds_read_b128 a[24:27], v3 offset:33792
    ds_read_b128 a[28:31], v3 offset:34304
    s_waitcnt lgkmcnt(7)
    v_mfma_f32_32x32x16_bf16 v[56:71], a[0:3], v[40:43], 0
    s_waitcnt lgkmcnt(6)
    v_mfma_f32_32x32x16_bf16 v[56:71], a[4:7], v[44:47], v[56:71]
    s_waitcnt lgkmcnt(5)
    v_mfma_f32_32x32x16_bf16 v[56:71], a[8:11], v[40:43], v[56:71]
    s_waitcnt lgkmcnt(4)
    v_mfma_f32_32x32x16_bf16 v[56:71], a[12:15], v[44:47], v[56:71]
    s_waitcnt lgkmcnt(3)
    v_mfma_f32_32x32x16_bf16 v[56:71], a[16:19], v[40:43], v[56:71]
    s_waitcnt lgkmcnt(2)
    v_mfma_f32_32x32x16_bf16 v[56:71], a[20:23], v[44:47], v[56:71]
    s_waitcnt lgkmcnt(1)
    v_mfma_f32_32x32x16_bf16 v[56:71], a[24:27], v[40:43], v[56:71]
    s_waitcnt lgkmcnt(0)
    v_mfma_f32_32x32x16_bf16 v[56:71], a[28:31], v[44:47], v[56:71]
    s_nop 11
    v_pk_fma_f32 v[56:57], v[56:57], v[120:121], v[20:21]
    v_cvt_pk_bf16_f32 v136, v56, v57
    v_pk_fma_f32 v[58:59], v[58:59], v[122:123], v[22:23]
    v_cvt_pk_bf16_f32 v137, v58, v59
    v_pk_fma_f32 v[60:61], v[60:61], v[124:125], v[24:25]
    v_cvt_pk_bf16_f32 v138, v60, v61
    v_pk_fma_f32 v[62:63], v[62:63], v[126:127], v[26:27]
    v_cvt_pk_bf16_f32 v139, v62, v63
    ds_write_b128 v54, v[136:139] offset:12288
    v_pk_fma_f32 v[64:65], v[64:65], v[128:129], v[28:29]
    v_cvt_pk_bf16_f32 v140, v64, v65
    v_pk_fma_f32 v[66:67], v[66:67], v[130:131], v[30:31]
    v_cvt_pk_bf16_f32 v141, v66, v67
    v_pk_fma_f32 v[68:69], v[68:69], v[132:133], v[32:33]
    v_cvt_pk_bf16_f32 v142, v68, v69
    v_pk_fma_f32 v[70:71], v[70:71], v[134:135], v[34:35]
    v_cvt_pk_bf16_f32 v143, v70, v71
    ds_write_b128 v54, v[140:143] offset:12304
    s_waitcnt lgkmcnt(0)
    ds_read_b128 v[136:139], v15 offset:12288
    ds_read_b128 v[140:143], v15 offset:13312
    s_waitcnt lgkmcnt(1)
    buffer_store_dwordx4 v[136:139], v14, s[32:35], s71 offen
    s_waitcnt lgkmcnt(0)
    buffer_store_dwordx4 v[140:143], v48, s[32:35], s71 offen offset:1024
EXIT:
    s_endpgm
SPIN_go:
    s_mov_b32 s3, 0
LOOP_go:
    buffer_load_dword v7, v6, s[36:39], 0 offen sc1
    s_add_u32 s3, s3, 1
    s_cmp_gt_u32 s3, 20000
    s_cbranch_scc1 BACK_go
    s_waitcnt vmcnt(0)
    v_cmp_ne_u32 vcc, 1, v7
    s_cbranch_vccnz LOOP_go
    s_branch BACK_go
SPIN_z:
    s_mov_b32 s3, 0
LOOP_z:
    buffer_load_dword v7, v6, s[40:43], s60 offen sc1
    s_add_u32 s3, s3, 1
    s_cmp_gt_u32 s3, 20000
    s_cbranch_scc1 BACK_z
    s_waitcnt vmcnt(0)
    v_cmp_ne_u32 vcc, 1, v7
    s_cbranch_vccnz LOOP_z
    s_branch BACK_z
ZRETRY:
    s_mov_b32 s3, 0
ZLOOP:
    s_nop 7
    buffer_load_dwordx4 a[224:227], v18, s[40:43], s69 offen offset:0 sc1
    buffer_load_dwordx4 a[228:231], v18, s[40:43], s69 offen offset:1024 sc1
    buffer_load_dwordx4 a[232:235], v18, s[40:43], s69 offen offset:2048 sc1
    buffer_load_dwordx4 a[236:239], v18, s[40:43], s69 offen offset:3072 sc1
    s_waitcnt vmcnt(0)
    v_mfma_f32_16x16x32_bf16 v[24:27], v[128:131], a[224:227], 0
    v_mfma_f32_16x16x32_bf16 v[28:31], v[144:147], a[224:227], 0
    v_mfma_f32_16x16x32_bf16 v[32:35], v[160:163], a[224:227], 0
    v_mfma_f32_16x16x32_bf16 v[36:39], v[176:179], a[224:227], 0
    v_mfma_f32_16x16x32_bf16 v[24:27], v[132:135], a[228:231], v[24:27]
    v_mfma_f32_16x16x32_bf16 v[28:31], v[148:151], a[228:231], v[28:31]
    v_mfma_f32_16x16x32_bf16 v[32:35], v[164:167], a[228:231], v[32:35]
    v_mfma_f32_16x16x32_bf16 v[36:39], v[180:183], a[228:231], v[36:39]
    v_mfma_f32_16x16x32_bf16 v[24:27], v[136:139], a[232:235], v[24:27]
    v_mfma_f32_16x16x32_bf16 v[28:31], v[152:155], a[232:235], v[28:31]
    v_mfma_f32_16x16x32_bf16 v[32:35], v[168:171], a[232:235], v[32:35]
    v_mfma_f32_16x16x32_bf16 v[36:39], v[184:187], a[232:235], v[36:39]
    v_mfma_f32_16x16x32_bf16 v[24:27], v[140:143], a[236:239], v[24:27]
    v_mfma_f32_16x16x32_bf16 v[28:31], v[156:159], a[236:239], v[28:31]
    v_mfma_f32_16x16x32_bf16 v[32:35], v[172:175], a[236:239], v[32:35]
    v_mfma_f32_16x16x32_bf16 v[36:39], v[188:191], a[236:239], v[36:39]
    s_nop 7
    s_nop 7
    s_add_u32 s3, s3, 1
    s_cmp_gt_u32 s3, 4000
    s_cbranch_scc1 ZBACK
    v_cmp_u_f32 vcc, v24, v24
    s_cbranch_vccnz ZLOOP
    s_branch ZBACK
SPIN_h:
    s_mov_b32 s3, 0
LOOP_h:
    buffer_load_dword v7, v6, s[40:43], s60 offen sc1
    s_add_u32 s3, s3, 1
    s_cmp_gt_u32 s3, 20000
    s_cbranch_scc1 BACK_h
    s_waitcnt vmcnt(0)
    v_cmp_ne_u32 vcc, 1, v7
    s_cbranch_vccnz LOOP_h
    s_branch BACK_h
SPIN_y:
    s_mov_b32 s3, 0
LOOP_y:
    buffer_load_dword v7, v6, s[40:43], s60 offen sc1
    s_add_u32 s3, s3, 1
    s_cmp_gt_u32 s3, 20000
    s_cbranch_scc1 BACK_y
    s_waitcnt vmcnt(0)
    v_cmp_ne_u32 vcc, 1, v7
    s_cbranch_vccnz LOOP_y
    s_branch BACK_y
CODE_END:
    s_endpgm
.section .rodata,"a"
.p2align 6
.amdhsa_kernel recurrent_scan__spectral_gfnet__mixer_channel_mlp__prompt_kernel
  .amdhsa_next_free_vgpr 512
  .amdhsa_next_free_sgpr 102
  .amdhsa_accum_offset 256
  .amdhsa_group_segment_fixed_size 0
  .amdhsa_kernarg_size 88
  .amdhsa_user_sgpr_count 2
  .amdhsa_user_sgpr_kernarg_segment_ptr 1
  .amdhsa_system_sgpr_workgroup_id_x 1
.end_amdhsa_kernel
```
